```python
import torch

def _softmax(x, axis=-1):
    return torch.softmax(x, dim=axis)
def _gelu(x):
    return torch.nn.functional.gelu(x, approximate="tanh")
def _silu(x):
    return torch.nn.functional.silu(x)
def _sigmoid(x):
    return torch.sigmoid(x)
def _layernorm(x, axis=-1, eps=1e-5):
    m = x.mean(dim=axis, keepdim=True)
    v = x.var(dim=axis, keepdim=True, unbiased=False)
    return (x - m) / torch.sqrt(v + eps)
def _scatter_add(tgt, idx, src, axis=0):
    return tgt.clone().index_add_(axis, idx, src)
def _segment_sum(src, seg, n):
    out = torch.zeros((n,) + src.shape[1:], dtype=src.dtype)
    return out.index_add_(0, seg, src)
def _pad(x, pw):
    flat = tuple(v for pair in reversed(pw) for v in pair)
    return torch.nn.functional.pad(x, flat)

kernel_name = 'concat_heads__compressed_kv_cla__gqa_block_cached__decode'

def setup_inputs():

    _w = (lambda a: (lambda t: t.to(torch.bfloat16) if t.is_floating_point() else t)(torch.as_tensor(a)))
    def _A_setup():
        B, H, Sq, Sk, D, M = 1, 32, 1, 16384, 128, 512
        Dc = 4 * D
        return {
            "x": _w((lambda *s: torch.randn(*s, dtype=torch.bfloat16) * 3.2)(B, Sq, M)),
            "c_kv": _w((lambda *s: torch.randn(*s, dtype=torch.bfloat16) * 0.1)(B, Sk, Dc)),
            "w_q": _w((lambda *s: torch.randn(*s, dtype=torch.bfloat16) * 6.4)(M, H, D) * (M ** -0.5)),
            "w_uk": _w((lambda *s: torch.randn(*s, dtype=torch.bfloat16) * 6.4)(Dc, H, D) * (Dc ** -0.5)),
            "w_uv": _w((lambda *s: torch.randn(*s, dtype=torch.bfloat16) * 0.1)(Dc, H, D) * (Dc ** -0.5)),
            "w_o": _w((lambda *s: torch.randn(*s, dtype=torch.bfloat16) * 0.1)(H, D, M) * ((H * D) ** -0.5)),
        }
    _A_in = _A_setup()

    def _B_setup():
        B, Sq, D = 1, 1, 512
        Hq, Hkv, Sk, Dh = 32, 8, 16384, 128
        assert Hq % Hkv == 0, (Hq, Hkv)
        return {
            "x": _w((lambda *s: torch.randn(*s, dtype=torch.bfloat16) * 1.6)(B, Sq, D)),
            "k_cache": _w((lambda *s: torch.randn(*s, dtype=torch.bfloat16) * 1.6)(B, Hkv, Sk, Dh)),
            "v_cache": _w((lambda *s: torch.randn(*s, dtype=torch.bfloat16) * 0.05)(B, Hkv, Sk, Dh)),
            "wq": _w((lambda *s: torch.randn(*s, dtype=torch.bfloat16) * 1.6)(D, Hq * Dh) * (D ** -0.5)),
            "wo": _w((lambda *s: torch.randn(*s, dtype=torch.bfloat16) * 0.05)(Hq * Dh, D) * ((Hq * Dh) ** -0.5)),
        }
    _B_in = _B_setup()

    return {
        "A_x": _A_in["x"],
        "A_c_kv": _A_in["c_kv"],
        "A_w_q": _A_in["w_q"],
        "A_w_uk": _A_in["w_uk"],
        "A_w_uv": _A_in["w_uv"],
        "A_w_o": _A_in["w_o"],
        "B_x": _B_in["x"],
        "B_k_cache": _B_in["k_cache"],
        "B_v_cache": _B_in["v_cache"],
        "B_wq": _B_in["wq"],
        "B_wo": _B_in["wo"],
    }

def reference(A_x, A_c_kv, A_w_q, A_w_uk, A_w_uv, A_w_o, B_x, B_k_cache, B_v_cache, B_wq, B_wo):
    def _A_ref(x, c_kv, w_q, w_uk, w_uv, w_o):
        B, Sq, M = x.shape[0], x.shape[1], x.shape[2]
        Sk = c_kv.shape[1]
        H, D = w_q.shape[1], w_q.shape[2]
        q = torch.einsum("bqm,mhd->bhqd", x, w_q)
        k = torch.einsum("bkc,chd->bhkd", c_kv, w_uk)
        v = torch.einsum("bkc,chd->bhkd", c_kv, w_uv)
        scores = torch.einsum("bhqd,bhkd->bhqk", q, k) * (D ** -0.5)
        off = Sk - Sq
        qi = torch.arange(Sq)[:, None]
        kj = torch.arange(Sk)[None, :]
        cmask = kj <= (qi + off)
        scores = torch.where(cmask[None, None], scores, -1e9)
        p = _softmax(scores, axis=-1)
        ctx = torch.einsum("bhqk,bhkd->bhqd", p, v)
        return torch.einsum("bhqd,hdm->bqm", ctx, w_o)

    def _B_ref(x, k_cache, v_cache, wq, wo):
        B, Sq, D = x.shape
        Hq, Dh = 32, 128
        Hkv = k_cache.shape[1]
        rep = Hq // Hkv
        q = (lambda x, *d: x.permute(*d))((x @ wq).reshape(B, Sq, Hq, Dh), 0, 2, 1, 3)
        k = (lambda x, n, axis: torch.repeat_interleave(x, n, dim=axis))(k_cache, rep, axis=1)
        v = (lambda x, n, axis: torch.repeat_interleave(x, n, dim=axis))(v_cache, rep, axis=1)
        scores = torch.einsum("bhqd,bhkd->bhqk", q, k) * (Dh ** -0.5)
        p = _softmax(scores, axis=-1)
        o = torch.einsum("bhqk,bhkd->bhqd", p, v)
        return (lambda x, *d: x.permute(*d))(o, 0, 2, 1, 3).reshape(B, Sq, Hq * Dh) @ wo

    a = _A_ref(A_x, A_c_kv, A_w_q, A_w_uk, A_w_uv, A_w_o)
    b = _B_ref(B_x, B_k_cache, B_v_cache, B_wq, B_wo)
    return torch.concatenate([a, b], axis=-1)
```

```asm
; @launch grid=(256,1,1) block=(512,1,1) lds=163840
.amdgcn_target "amdgcn-amd-amdhsa--gfx950"
.text
.globl concat_heads__compressed_kv_cla__gqa_block_cached__decode_kernel
.p2align 8
.type concat_heads__compressed_kv_cla__gqa_block_cached__decode_kernel,@function
concat_heads__compressed_kv_cla__gqa_block_cached__decode_kernel:
    s_cmp_ge_u32 s2, 256
    s_cbranch_scc1 L_end
    s_load_dwordx16 s[4:19], s[0:1], 0
    s_load_dwordx8 s[20:27], s[0:1], 64
    s_load_dwordx4 s[28:31], s[0:1], 96
    v_lshrrev_b32 v1, 6, v0
    v_and_b32 v0, 63, v0
    s_bfe_u32 s33, s2, 0x20003
    v_readfirstlane_b32 s32, v1
    s_nop 0
    s_cmp_eq_u32 s32, 6
    s_nop 1
    s_cbranch_scc0 L_nopf
    s_getpc_b64 s[60:61]
L_pc:
    s_lshl_b32 s62, s33, 13
    v_lshl_add_u32 v2, v0, 7, s62
    v_min_u32 v2, L_end-L_pc, v2
    global_load_dword v27, v2, s[60:61]
    s_nop 0
L_nopf:
    s_mov_b32 s80, 0x05040100
    s_mov_b32 s81, 0x07060302
    s_mov_b32 s82, 0x3e0293ee
    s_mov_b32 s88, 0xffff0000
    s_mov_b32 s89, 0xffff0000
    s_cmp_eq_u32 s33, 3
    s_cbranch_scc1 L_notpf
    s_cmp_lt_u32 s32, 4
    s_cbranch_scc0 L_nopf1_x
    s_mul_i32 s57, s32, 24
    s_lshl_b32 s56, s33, 3
    s_add_u32 s57, s57, s56
    s_lshr_b32 s56, s2, 5
    s_add_u32 s57, s57, s56
    s_mul_i32 s58, s57, 171
    s_lshr_b32 s58, s58, 11
    s_mul_i32 s59, s58, 12
    s_sub_u32 s59, s57, s59
    s_add_u32 s59, s59, 4
    s_and_b32 s57, s2, 7
    s_lshl_b32 s57, s57, 3
    s_add_u32 s58, s58, s57
    s_lshl_b32 s58, s58, 7
    s_and_b32 s57, s59, 7
    s_lshl_b32 s57, s57, 19
    s_add_u32 s58, s58, s57
    v_lshl_add_u32 v8, v0, 13, s58
    s_cmp_lt_u32 s59, 8
    s_waitcnt lgkmcnt(0)
    s_cselect_b32 s58, s8, s10
    s_cselect_b32 s59, s9, s11
    global_load_dword v26, v8, s[58:59]
L_nopf1_x:
    s_barrier
L_notpf:
    s_cmp_eq_u32 s33, 0
    s_cbranch_scc1 L_A
    s_and_b32 s34, s2, 7
    s_lshr_b32 s60, s2, 5
    s_lshl_b32 s35, s33, 3
    s_add_u32 s35, s35, s60
    s_sub_u32 s35, s35, 8
    s_sub_i32 s61, s35, 16
    s_max_i32 s61, s61, 0
    s_min_i32 s61, s61, 8
    s_mul_i32 s60, s35, 21
    s_add_u32 s60, s60, s61
    s_mul_i32 s61, s32, 3
    s_add_u32 s60, s60, s61
    s_lshl_b32 s60, s60, 13
    s_lshl_b32 s61, s34, 22
    s_add_u32 s62, s60, s61
    v_and_b32 v1, 3, v0
    v_lshlrev_b32 v1, 4, v1
    v_bfe_u32 v2, v0, 2, 2
    v_lshl_add_u32 v1, v2, 8, v1
    v_lshrrev_b32 v3, 4, v0
    v_lshl_add_u32 v1, v3, 6, v1
    v_lshlrev_b32 v2, 4, v0
    s_waitcnt lgkmcnt(0)
    s_mov_b32 s36, s18
    s_mov_b32 s37, s19
    s_mov_b32 s38, 33554432
    s_mov_b32 s39, 0x20000
    s_mov_b32 s40, s20
    s_mov_b32 s41, s21
    s_mov_b32 s42, 33554432
    s_mov_b32 s43, 0x20000
    s_cmp_eq_u32 s33, 3
    s_cbranch_scc1 L_BY
    s_cmp_eq_u32 s32, 7
    s_cbranch_scc1 L_B7X
    s_add_u32 s63, s62, 0
    s_waitcnt vmcnt(0)
    buffer_load_dwordx4 v[160:163], v2, s[40:43], s63 offen offset:0 nt
    s_waitcnt vmcnt(0)
    buffer_load_dwordx4 v[164:167], v2, s[40:43], s63 offen offset:1024 nt
    s_mul_i32 s57, s32, 16
    s_add_u32 s57, s57, s35
    s_mov_b32 s58, s34
    s_cmp_lt_u32 s57, 64
    s_cbranch_scc0 L_pfj_1
    s_lshr_b32 s59, s57, 3
    s_and_b32 s57, s57, 7
    s_lshl_b32 s59, s59, 21
    s_lshl_b32 s57, s57, 13
    s_add_u32 s59, s59, s57
    s_lshl_b32 s58, s58, 18
    s_add_u32 s59, s59, s58
    s_add_u32 s59, s59, 65536
    v_lshl_add_u32 v8, v0, 7, s59
    global_load_dword v26, v8, s[6:7]
    s_nop 0
L_pfj_1:
    buffer_load_dwordx4 v[168:171], v2, s[40:43], s63 offen offset:2048 nt
    s_waitcnt vmcnt(1)
    buffer_load_dwordx4 v[172:175], v2, s[40:43], s63 offen offset:3072 nt
    s_add_u32 s63, s62, 0
    buffer_load_dwordx4 v[64:67], v1, s[36:39], s63 offen offset:0 nt
    buffer_load_dwordx4 v[68:71], v1, s[36:39], s63 offen offset:1024 nt
    s_waitcnt vmcnt(3)
    buffer_load_dwordx4 v[72:75], v1, s[36:39], s63 offen offset:2048 nt
    s_waitcnt vmcnt(3)
    buffer_load_dwordx4 v[76:79], v1, s[36:39], s63 offen offset:3072 nt
    s_add_u32 s63, s62, 4096
    s_waitcnt vmcnt(3)
    buffer_load_dwordx4 v[80:83], v1, s[36:39], s63 offen offset:0 nt
    s_mul_i32 s57, s32, 24
    s_add_u32 s57, s57, s35
    s_mov_b32 s58, s34
    s_sub_u32 s59, s57, 124
    s_cmp_lt_u32 s59, 4
    s_cselect_b32 s57, 999, s57
    s_sub_u32 s59, s57, 132
    s_add_u32 s56, s59, 124
    s_cmp_lt_u32 s59, 4
    s_cselect_b32 s57, s56, s57
    s_mul_i32 s59, s32, 24
    s_add_u32 s59, s59, 19
    s_cmp_eq_u32 s57, s59
    s_cselect_b32 s57, 999, s57
    s_cmp_eq_u32 s57, 136
    s_cselect_b32 s57, 132, s57
    s_sub_u32 s59, s57, 128
    s_mul_i32 s56, s59, 24
    s_add_u32 s56, s56, 19
    s_cmp_lt_u32 s59, 5
    s_cselect_b32 s57, s56, s57
    s_cmp_lt_u32 s57, 128
    s_cbranch_scc0 L_pfj_2
    s_lshr_b32 s59, s57, 4
    s_and_b32 s57, s57, 15
    s_lshl_b32 s59, s59, 21
    s_lshl_b32 s57, s57, 13
    s_add_u32 s59, s59, s57
    s_lshl_b32 s58, s58, 18
    s_add_u32 s59, s59, s58
    s_add_u32 s59, s59, 131072
    v_lshl_add_u32 v8, v0, 7, s59
    global_load_dword v26, v8, s[6:7]
    s_nop 0
L_pfj_2:
    s_waitcnt vmcnt(3)
    buffer_load_dwordx4 v[84:87], v1, s[36:39], s63 offen offset:1024 nt
    s_waitcnt vmcnt(3)
    buffer_load_dwordx4 v[88:91], v1, s[36:39], s63 offen offset:2048 nt
    s_mul_i32 s57, s32, 24
    s_add_u32 s57, s57, s35
    s_mov_b32 s58, s34
    s_cmp_lt_u32 s57, 64
    s_cbranch_scc0 L_pfj_3
    s_lshr_b32 s59, s57, 3
    s_and_b32 s57, s57, 7
    s_lshl_b32 s58, s58, 3
    s_add_u32 s59, s59, s58
    s_and_b32 s58, s57, 7
    s_cmp_lt_u32 s57, 8
    s_cselect_b32 s56, 7, 16
    s_cselect_b32 s57, 19, 13
    s_cselect_b32 s61, 13, 7
    s_cselect_b32 s60, s12, s14
    s_lshl_b32 s59, s59, s56
    s_lshl_b32 s58, s58, s57
    s_add_u32 s59, s59, s58
    v_lshlrev_b32 v8, s61, v0
    s_cmp_eq_u32 s61, 13
    s_cselect_b32 s61, s13, s15
    v_add_u32 v8, s59, v8
    global_load_dword v26, v8, s[60:61]
    s_nop 0
L_pfj_3:
    s_waitcnt vmcnt(3)
    buffer_load_dwordx4 v[92:95], v1, s[36:39], s63 offen offset:3072 nt
    s_add_u32 s63, s62, 8192
    s_waitcnt vmcnt(3)
    buffer_load_dwordx4 v[96:99], v1, s[36:39], s63 offen offset:0 nt
    s_waitcnt vmcnt(3)
    buffer_load_dwordx4 v[100:103], v1, s[36:39], s63 offen offset:1024 nt
    s_waitcnt vmcnt(3)
    buffer_load_dwordx4 v[104:107], v1, s[36:39], s63 offen offset:2048 nt
    s_waitcnt vmcnt(3)
    buffer_load_dwordx4 v[108:111], v1, s[36:39], s63 offen offset:3072 nt
    s_add_u32 s63, s62, 12288
    s_waitcnt vmcnt(3)
    buffer_load_dwordx4 v[112:115], v1, s[36:39], s63 offen offset:0 nt
    s_waitcnt vmcnt(3)
    buffer_load_dwordx4 v[116:119], v1, s[36:39], s63 offen offset:1024 nt
    s_waitcnt vmcnt(3)
    buffer_load_dwordx4 v[120:123], v1, s[36:39], s63 offen offset:2048 nt
    s_waitcnt vmcnt(3)
    buffer_load_dwordx4 v[124:127], v1, s[36:39], s63 offen offset:3072 nt
    s_add_u32 s63, s62, 16384
    s_waitcnt vmcnt(3)
    buffer_load_dwordx4 v[128:131], v1, s[36:39], s63 offen offset:0 nt
    s_waitcnt vmcnt(3)
    buffer_load_dwordx4 v[132:135], v1, s[36:39], s63 offen offset:1024 nt
    s_waitcnt vmcnt(3)
    buffer_load_dwordx4 v[136:139], v1, s[36:39], s63 offen offset:2048 nt
    s_waitcnt vmcnt(3)
    buffer_load_dwordx4 v[140:143], v1, s[36:39], s63 offen offset:3072 nt
    s_add_u32 s63, s62, 20480
    s_waitcnt vmcnt(3)
    buffer_load_dwordx4 v[144:147], v1, s[36:39], s63 offen offset:0 nt
    s_waitcnt vmcnt(3)
    buffer_load_dwordx4 v[148:151], v1, s[36:39], s63 offen offset:1024 nt
    s_waitcnt vmcnt(3)
    buffer_load_dwordx4 v[152:155], v1, s[36:39], s63 offen offset:2048 nt
    s_waitcnt vmcnt(3)
    buffer_load_dwordx4 v[156:159], v1, s[36:39], s63 offen offset:3072 nt
    s_mov_b32 s48, s30
    s_mov_b32 s49, s31
    s_mov_b32 s50, 8388608
    s_mov_b32 s51, 0x20000
    s_branch L_B06
L_BY:
    s_load_dword s84, s[30:31], 155648
    s_lshl_b32 s87, s34, 3
    s_add_u32 s87, s87, s35
    s_sub_u32 s87, s87, 16
    s_lshl_b32 s86, s32, 19
    s_lshl_b32 s60, s87, 7
    s_add_u32 s86, s86, s60
    v_bfe_u32 v8, v0, 3, 1
    v_lshlrev_b32 v8, 18, v8
    v_lshl_add_u32 v8, v3, 16, v8
    v_and_b32 v4, 7, v0
    v_lshl_add_u32 v8, v4, 4, v8
    v_and_b32 v5, 1, v0
    v_lshlrev_b32 v5, 6, v5
    v_lshl_add_u32 v5, v3, 4, v5
    s_lshl_b32 s61, s32, 7
    s_mov_b32 s44, s8
    s_mov_b32 s45, s9
    s_mov_b32 s46, 4194304
    s_mov_b32 s47, 0x20000
    s_mov_b32 s52, s4
    s_mov_b32 s53, s5
    s_mov_b32 s54, 1024
    s_mov_b32 s55, 0x20000
    buffer_load_dwordx4 v[28:31], v5, s[52:55], s61 offen
    s_add_u32 s63, s86, 0
    buffer_load_dwordx4 v[192:195], v8, s[44:47], s63 offen nt
    s_add_u32 s63, s86, 8192
    buffer_load_dwordx4 v[196:199], v8, s[44:47], s63 offen nt
    s_add_u32 s63, s86, 16384
    buffer_load_dwordx4 v[200:203], v8, s[44:47], s63 offen nt
    s_add_u32 s63, s86, 24576
    buffer_load_dwordx4 v[204:207], v8, s[44:47], s63 offen nt
    s_add_u32 s63, s86, 32768
    buffer_load_dwordx4 v[208:211], v8, s[44:47], s63 offen nt
    s_add_u32 s63, s86, 40960
    buffer_load_dwordx4 v[212:215], v8, s[44:47], s63 offen nt
    s_add_u32 s63, s86, 49152
    buffer_load_dwordx4 v[216:219], v8, s[44:47], s63 offen nt
    s_add_u32 s63, s86, 57344
    buffer_load_dwordx4 v[220:223], v8, s[44:47], s63 offen nt
    s_mov_b32 s52, s10
    s_mov_b32 s53, s11
    s_mov_b32 s54, 4194304
    s_mov_b32 s55, 0x20000
    v_lshrrev_b32 v6, 5, v0
    v_lshlrev_b32 v6, 18, v6
    v_bfe_u32 v7, v0, 2, 2
    v_lshl_add_u32 v6, v7, 16, v6
    v_bfe_u32 v7, v0, 4, 1
    v_lshl_add_u32 v6, v7, 6, v6
    v_and_b32 v7, 3, v0
    v_lshl_add_u32 v6, v7, 4, v6
    s_barrier
    s_add_u32 s63, s86, 0
    buffer_load_dwordx4 v[224:227], v6, s[52:55], s63 offen nt
    s_add_u32 s63, s86, 8192
    buffer_load_dwordx4 v[228:231], v6, s[52:55], s63 offen nt
    s_add_u32 s63, s86, 16384
    buffer_load_dwordx4 v[232:235], v6, s[52:55], s63 offen nt
    s_add_u32 s63, s86, 24576
    buffer_load_dwordx4 v[236:239], v6, s[52:55], s63 offen nt
    s_add_u32 s63, s86, 32768
    buffer_load_dwordx4 v[240:243], v6, s[52:55], s63 offen nt
    s_add_u32 s63, s86, 40960
    buffer_load_dwordx4 v[244:247], v6, s[52:55], s63 offen nt
    s_add_u32 s63, s86, 49152
    buffer_load_dwordx4 v[248:251], v6, s[52:55], s63 offen nt
    s_add_u32 s63, s86, 57344
    buffer_load_dwordx4 v[252:255], v6, s[52:55], s63 offen nt
    s_mov_b32 s48, s30
    s_mov_b32 s49, s31
    s_mov_b32 s50, 8388608
    s_mov_b32 s51, 0x20000
    v_and_b32 v8, 15, v0
    v_lshlrev_b32 v8, 5, v8
    v_lshl_add_u32 v8, v3, 3, v8
    s_lshl_b32 s60, s32, 8
    v_add_u32 v8, s60, v8
    s_lshl_b32 s60, s32, 7
    v_lshlrev_b32 v12, 2, v0
    v_lshl_add_u32 v13, v0, 1, s60
    v_bfe_u32 v9, v0, 4, 1
    v_lshl_add_u32 v9, v9, 2, v7
    v_lshl_add_u32 v9, v9, 4, s60
    s_waitcnt vmcnt(14)
    v_perm_b32 v128, v196, v192, s80
    v_perm_b32 v132, v196, v192, s81
    v_perm_b32 v136, v197, v193, s80
    v_perm_b32 v140, v197, v193, s81
    v_perm_b32 v144, v198, v194, s80
    v_perm_b32 v148, v198, v194, s81
    v_perm_b32 v152, v199, v195, s80
    v_perm_b32 v156, v199, v195, s81
    s_waitcnt vmcnt(12)
    v_perm_b32 v129, v204, v200, s80
    v_perm_b32 v133, v204, v200, s81
    v_perm_b32 v137, v205, v201, s80
    v_perm_b32 v141, v205, v201, s81
    v_perm_b32 v145, v206, v202, s80
    v_perm_b32 v149, v206, v202, s81
    v_perm_b32 v153, v207, v203, s80
    v_perm_b32 v157, v207, v203, s81
    s_waitcnt vmcnt(10)
    v_perm_b32 v130, v212, v208, s80
    v_perm_b32 v134, v212, v208, s81
    v_perm_b32 v138, v213, v209, s80
    v_perm_b32 v142, v213, v209, s81
    v_perm_b32 v146, v214, v210, s80
    v_perm_b32 v150, v214, v210, s81
    v_perm_b32 v154, v215, v211, s80
    v_perm_b32 v158, v215, v211, s81
    s_waitcnt vmcnt(8)
    v_perm_b32 v131, v220, v216, s80
    v_perm_b32 v135, v220, v216, s81
    v_perm_b32 v139, v221, v217, s80
    v_perm_b32 v143, v221, v217, s81
    v_perm_b32 v147, v222, v218, s80
    v_perm_b32 v151, v222, v218, s81
    v_perm_b32 v155, v223, v219, s80
    v_perm_b32 v159, v223, v219, s81
    v_mfma_f32_16x16x32_bf16 v[32:35], v[28:31], v[128:131], 0
    v_mfma_f32_16x16x32_bf16 v[36:39], v[28:31], v[132:135], 0
    v_mfma_f32_16x16x32_bf16 v[40:43], v[28:31], v[136:139], 0
    v_mfma_f32_16x16x32_bf16 v[44:47], v[28:31], v[140:143], 0
    v_mfma_f32_16x16x32_bf16 v[48:51], v[28:31], v[144:147], 0
    v_mfma_f32_16x16x32_bf16 v[52:55], v[28:31], v[148:151], 0
    v_mfma_f32_16x16x32_bf16 v[56:59], v[28:31], v[152:155], 0
    v_mfma_f32_16x16x32_bf16 v[60:63], v[28:31], v[156:159], 0
    s_nop 0
    v_add_f32_dpp v64, v33, v32 row_shl:8 row_mask:0xf bank_mask:0xf
    v_add_f32_dpp v65, v37, v36 row_shl:8 row_mask:0xf bank_mask:0xf
    v_add_f32_dpp v66, v41, v40 row_shl:8 row_mask:0xf bank_mask:0xf
    v_add_f32_dpp v67, v45, v44 row_shl:8 row_mask:0xf bank_mask:0xf
    v_add_f32_dpp v68, v49, v48 row_shl:8 row_mask:0xf bank_mask:0xf
    v_add_f32_dpp v69, v53, v52 row_shl:8 row_mask:0xf bank_mask:0xf
    v_add_f32_dpp v70, v57, v56 row_shl:8 row_mask:0xf bank_mask:0xf
    v_add_f32_dpp v71, v61, v60 row_shl:8 row_mask:0xf bank_mask:0xf
    v_cndmask_b32 v64, v64, v66, s[88:89]
    v_cndmask_b32 v68, v68, v70, s[88:89]
    v_cndmask_b32 v65, v65, v67, s[88:89]
    v_cndmask_b32 v69, v69, v71, s[88:89]
    s_mov_b32 vcc_lo, 0
    s_mov_b32 vcc_hi, -1
    v_cndmask_b32 v64, v64, v68, vcc
    v_cndmask_b32 v65, v65, v69, vcc
    s_mov_b32 exec_lo, 0x00ff00ff
    s_mov_b32 exec_hi, 0x00ff00ff
    ds_write_b64 v8, v[64:65] offset:32768
    s_mov_b64 exec, -1
    s_waitcnt lgkmcnt(0)
    s_barrier
    s_cmp_eq_u32 s32, 7
    s_cselect_b32 s63, 33554432, s62
    ds_read2st64_b32 v[64:65], v12 offset0:128 offset1:129
    ds_read2st64_b32 v[66:67], v12 offset0:130 offset1:131
    ds_read2st64_b32 v[68:69], v12 offset0:132 offset1:133
    ds_read2st64_b32 v[70:71], v12 offset0:134 offset1:135
    s_waitcnt lgkmcnt(2)
    v_pk_add_f32 v[64:65], v[64:65], v[66:67]
    s_waitcnt lgkmcnt(0)
    v_pk_add_f32 v[68:69], v[68:69], v[70:71]
    v_pk_add_f32 v[64:65], v[64:65], v[68:69]
    v_add_f32 v64, v64, v65
    v_cvt_pk_bf16_f32 v64, v64, v64
    ds_write_b16 v13, v64 offset:34816
    ds_read_b128 v[28:31], v9 offset:34816
    s_waitcnt lgkmcnt(0)
    v_lshrrev_b32 v10, 5, v0
    v_bfe_u32 v11, v0, 2, 1
    v_cmp_eq_u32 vcc, v10, v11
    s_nop 1
    v_cndmask_b32 v28, 0, v28, vcc
    v_cndmask_b32 v29, 0, v29, vcc
    v_cndmask_b32 v30, 0, v30, vcc
    v_cndmask_b32 v31, 0, v31, vcc
    s_waitcnt vmcnt(0)
    s_nop 0
    v_mfma_f32_16x16x32_bf16 v[32:35], v[224:227], v[28:31], 0
    v_mfma_f32_16x16x32_bf16 v[36:39], v[228:231], v[28:31], 0
    v_mfma_f32_16x16x32_bf16 v[40:43], v[232:235], v[28:31], 0
    v_mfma_f32_16x16x32_bf16 v[44:47], v[236:239], v[28:31], 0
    v_mfma_f32_16x16x32_bf16 v[48:51], v[240:243], v[28:31], 0
    v_mfma_f32_16x16x32_bf16 v[52:55], v[244:247], v[28:31], 0
    v_mfma_f32_16x16x32_bf16 v[56:59], v[248:251], v[28:31], 0
    v_mfma_f32_16x16x32_bf16 v[60:63], v[252:255], v[28:31], 0
    v_bfe_u32 v10, v0, 2, 1
    v_lshlrev_b32 v10, 6, v10
    v_lshl_add_u32 v10, v3, 4, v10
    s_lshl_b32 s60, s32, 7
    v_add_u32 v10, s60, v10
    v_add_f32_dpp v64, v33, v32 row_shl:1 row_mask:0xf bank_mask:0xf
    v_add_f32_dpp v65, v37, v36 row_shl:1 row_mask:0xf bank_mask:0xf
    v_add_f32_dpp v66, v41, v40 row_shl:1 row_mask:0xf bank_mask:0xf
    v_add_f32_dpp v67, v45, v44 row_shl:1 row_mask:0xf bank_mask:0xf
    v_add_f32_dpp v68, v49, v48 row_shl:1 row_mask:0xf bank_mask:0xf
    v_add_f32_dpp v69, v53, v52 row_shl:1 row_mask:0xf bank_mask:0xf
    v_add_f32_dpp v70, v57, v56 row_shl:1 row_mask:0xf bank_mask:0xf
    v_add_f32_dpp v71, v61, v60 row_shl:1 row_mask:0xf bank_mask:0xf
    v_add_f32_dpp v34, v35, v34 row_shl:1 row_mask:0xf bank_mask:0xf
    v_add_f32_dpp v38, v39, v38 row_shl:1 row_mask:0xf bank_mask:0xf
    v_add_f32_dpp v42, v43, v42 row_shl:1 row_mask:0xf bank_mask:0xf
    v_add_f32_dpp v46, v47, v46 row_shl:1 row_mask:0xf bank_mask:0xf
    v_add_f32_dpp v50, v51, v50 row_shl:1 row_mask:0xf bank_mask:0xf
    v_add_f32_dpp v54, v55, v54 row_shl:1 row_mask:0xf bank_mask:0xf
    v_add_f32_dpp v58, v59, v58 row_shl:1 row_mask:0xf bank_mask:0xf
    v_add_f32_dpp v62, v63, v62 row_shl:1 row_mask:0xf bank_mask:0xf
    v_add_f32_dpp v64, v34, v64 row_shl:2 row_mask:0xf bank_mask:0xf
    v_add_f32_dpp v65, v38, v65 row_shl:2 row_mask:0xf bank_mask:0xf
    v_add_f32_dpp v66, v42, v66 row_shl:2 row_mask:0xf bank_mask:0xf
    v_add_f32_dpp v67, v46, v67 row_shl:2 row_mask:0xf bank_mask:0xf
    v_add_f32_dpp v68, v50, v68 row_shl:2 row_mask:0xf bank_mask:0xf
    v_add_f32_dpp v69, v54, v69 row_shl:2 row_mask:0xf bank_mask:0xf
    v_add_f32_dpp v70, v58, v70 row_shl:2 row_mask:0xf bank_mask:0xf
    v_add_f32_dpp v71, v62, v71 row_shl:2 row_mask:0xf bank_mask:0xf
    v_cvt_pk_bf16_f32 v72, v64, v65
    v_cvt_pk_bf16_f32 v73, v66, v67
    v_cvt_pk_bf16_f32 v74, v68, v69
    v_cvt_pk_bf16_f32 v75, v70, v71
    s_mov_b32 exec_lo, 0x00110011
    s_mov_b32 exec_hi, 0x00110011
    ds_write_b128 v10, v[72:75] offset:36864
    s_mov_b64 exec, -1
    s_waitcnt lgkmcnt(0)
    s_barrier
    s_cmp_eq_u32 s32, 7
    s_cbranch_scc1 L_B7Y
    s_barrier
    s_add_u32 s63, s62, 0
    buffer_load_dwordx4 v[160:163], v2, s[40:43], s63 offen offset:0 nt
    buffer_load_dwordx4 v[164:167], v2, s[40:43], s63 offen offset:1024 nt
    buffer_load_dwordx4 v[168:171], v2, s[40:43], s63 offen offset:2048 nt
    buffer_load_dwordx4 v[172:175], v2, s[40:43], s63 offen offset:3072 nt
    s_add_u32 s63, s62, 0
    s_waitcnt vmcnt(3)
    buffer_load_dwordx4 v[64:67], v1, s[36:39], s63 offen offset:0 nt
    s_waitcnt vmcnt(3)
    buffer_load_dwordx4 v[68:71], v1, s[36:39], s63 offen offset:1024 nt
    s_waitcnt vmcnt(3)
    buffer_load_dwordx4 v[72:75], v1, s[36:39], s63 offen offset:2048 nt
    s_waitcnt vmcnt(3)
    buffer_load_dwordx4 v[76:79], v1, s[36:39], s63 offen offset:3072 nt
    s_add_u32 s63, s62, 4096
    s_waitcnt vmcnt(3)
    buffer_load_dwordx4 v[80:83], v1, s[36:39], s63 offen offset:0 nt
    s_waitcnt vmcnt(3)
    buffer_load_dwordx4 v[84:87], v1, s[36:39], s63 offen offset:1024 nt
    s_mul_i32 s57, s32, 24
    s_add_u32 s57, s57, s35
    s_mov_b32 s58, s34
    s_sub_u32 s59, s57, 124
    s_cmp_lt_u32 s59, 4
    s_cselect_b32 s57, 999, s57
    s_sub_u32 s59, s57, 132
    s_add_u32 s56, s59, 124
    s_cmp_lt_u32 s59, 4
    s_cselect_b32 s57, s56, s57
    s_mul_i32 s59, s32, 24
    s_add_u32 s59, s59, 19
    s_cmp_eq_u32 s57, s59
    s_cselect_b32 s57, 999, s57
    s_cmp_eq_u32 s57, 136
    s_cselect_b32 s57, 132, s57
    s_sub_u32 s59, s57, 128
    s_mul_i32 s56, s59, 24
    s_add_u32 s56, s56, 19
    s_cmp_lt_u32 s59, 5
    s_cselect_b32 s57, s56, s57
    s_cmp_lt_u32 s57, 128
    s_cbranch_scc0 L_pfj_5
    s_lshr_b32 s59, s57, 4
    s_and_b32 s57, s57, 15
    s_lshl_b32 s59, s59, 21
    s_lshl_b32 s57, s57, 13
    s_add_u32 s59, s59, s57
    s_lshl_b32 s58, s58, 18
    s_add_u32 s59, s59, s58
    s_add_u32 s59, s59, 131072
    v_lshl_add_u32 v8, v0, 7, s59
    global_load_dword v26, v8, s[6:7]
    s_nop 0
L_pfj_5:
    s_waitcnt vmcnt(3)
    buffer_load_dwordx4 v[88:91], v1, s[36:39], s63 offen offset:2048 nt
    s_mul_i32 s57, s32, 24
    s_add_u32 s57, s57, s35
    s_mov_b32 s58, s34
    s_cmp_lt_u32 s57, 64
    s_cbranch_scc0 L_pfj_6
    s_lshr_b32 s59, s57, 3
    s_and_b32 s57, s57, 7
    s_lshl_b32 s58, s58, 3
    s_add_u32 s59, s59, s58
    s_and_b32 s58, s57, 7
    s_cmp_lt_u32 s57, 8
    s_cselect_b32 s56, 7, 16
    s_cselect_b32 s57, 19, 13
    s_cselect_b32 s61, 13, 7
    s_cselect_b32 s60, s12, s14
    s_lshl_b32 s59, s59, s56
    s_lshl_b32 s58, s58, s57
    s_add_u32 s59, s59, s58
    v_lshlrev_b32 v8, s61, v0
    s_cmp_eq_u32 s61, 13
    s_cselect_b32 s61, s13, s15
    v_add_u32 v8, s59, v8
    global_load_dword v26, v8, s[60:61]
    s_nop 0
L_pfj_6:
    s_waitcnt vmcnt(3)
    buffer_load_dwordx4 v[92:95], v1, s[36:39], s63 offen offset:3072 nt
    s_add_u32 s63, s62, 8192
    s_waitcnt vmcnt(3)
    buffer_load_dwordx4 v[96:99], v1, s[36:39], s63 offen offset:0 nt
    s_waitcnt vmcnt(3)
    buffer_load_dwordx4 v[100:103], v1, s[36:39], s63 offen offset:1024 nt
    s_waitcnt vmcnt(3)
    buffer_load_dwordx4 v[104:107], v1, s[36:39], s63 offen offset:2048 nt
    s_waitcnt vmcnt(3)
    buffer_load_dwordx4 v[108:111], v1, s[36:39], s63 offen offset:3072 nt
    s_add_u32 s63, s62, 12288
    s_waitcnt vmcnt(3)
    buffer_load_dwordx4 v[112:115], v1, s[36:39], s63 offen offset:0 nt
    s_waitcnt vmcnt(3)
    buffer_load_dwordx4 v[116:119], v1, s[36:39], s63 offen offset:1024 nt
    s_waitcnt vmcnt(3)
    buffer_load_dwordx4 v[120:123], v1, s[36:39], s63 offen offset:2048 nt
    s_waitcnt vmcnt(3)
    buffer_load_dwordx4 v[124:127], v1, s[36:39], s63 offen offset:3072 nt
    s_add_u32 s63, s62, 16384
    s_waitcnt vmcnt(3)
    buffer_load_dwordx4 v[128:131], v1, s[36:39], s63 offen offset:0 nt
    s_waitcnt vmcnt(3)
    buffer_load_dwordx4 v[132:135], v1, s[36:39], s63 offen offset:1024 nt
    s_waitcnt vmcnt(3)
    buffer_load_dwordx4 v[136:139], v1, s[36:39], s63 offen offset:2048 nt
    s_waitcnt vmcnt(3)
    buffer_load_dwordx4 v[140:143], v1, s[36:39], s63 offen offset:3072 nt
    s_add_u32 s63, s62, 20480
    s_waitcnt vmcnt(3)
    buffer_load_dwordx4 v[144:147], v1, s[36:39], s63 offen offset:0 nt
    s_waitcnt vmcnt(3)
    buffer_load_dwordx4 v[148:151], v1, s[36:39], s63 offen offset:1024 nt
    s_waitcnt vmcnt(3)
    buffer_load_dwordx4 v[152:155], v1, s[36:39], s63 offen offset:2048 nt
    s_waitcnt vmcnt(3)
    buffer_load_dwordx4 v[156:159], v1, s[36:39], s63 offen offset:3072 nt
L_B06:
    s_load_dword s84, s[30:31], 155776
    s_add_u32 s63, s62, 4096
    s_waitcnt vmcnt(5)
    buffer_load_dwordx4 v[176:179], v2, s[40:43], s63 offen offset:0 nt
    s_add_u32 s63, s62, 4096
    s_waitcnt vmcnt(5)
    buffer_load_dwordx4 v[180:183], v2, s[40:43], s63 offen offset:1024 nt
    v_and_b32 v7, 3, v0
    v_lshlrev_b32 v7, 5, v7
    s_lshl_b32 s60, s32, 2
    v_add_u32 v6, s60, v7
    v_and_b32 v17, 3, v0
    v_mul_u32_u24 v17, 528, v17
    v_lshrrev_b32 v3, 4, v0
    v_lshl_add_u32 v17, v3, 4, v17
    s_mul_i32 s60, s32, 2112
    v_add_u32 v17, s60, v17
    v_mov_b32 v18, 0
    v_mov_b32 v19, 1
    s_waitcnt lgkmcnt(0)
    s_add_u32 s84, s84, 0x9e3779b9
    s_mov_b32 s85, s84
    s_bfe_u32 s72, s84, 0xc0000
    s_bfe_u32 s73, s84, 0xc0007
    s_bfe_u32 s74, s84, 0xc000e
    s_bfe_u32 s75, s84, 0xc0014
    s_movk_i32 s76, 0xfff
    v_mov_b32 v23, 0xfffff000
    s_barrier
    ds_read_b128 v[28:31], v2
    s_waitcnt lgkmcnt(0)
    v_mfma_f32_16x16x32_bf16 v[32:35], v[64:67], v[28:31], 0
    v_mfma_f32_16x16x32_bf16 v[36:39], v[68:71], v[28:31], 0
    v_mfma_f32_16x16x32_bf16 v[40:43], v[72:75], v[28:31], 0
    v_mfma_f32_16x16x32_bf16 v[44:47], v[76:79], v[28:31], 0
    v_mfma_f32_16x16x32_bf16 v[48:51], v[80:83], v[28:31], 0
    v_mfma_f32_16x16x32_bf16 v[52:55], v[84:87], v[28:31], 0
    v_mfma_f32_16x16x32_bf16 v[56:59], v[88:91], v[28:31], 0
    v_mfma_f32_16x16x32_bf16 v[60:63], v[92:95], v[28:31], 0
    s_nop 0
    v_add_f32_dpp v64, v33, v32 row_shl:4 row_mask:0xf bank_mask:0xf
    v_add_f32_dpp v65, v37, v36 row_shl:4 row_mask:0xf bank_mask:0xf
    v_add_f32_dpp v66, v41, v40 row_shl:4 row_mask:0xf bank_mask:0xf
    v_add_f32_dpp v67, v45, v44 row_shl:4 row_mask:0xf bank_mask:0xf
    v_add_f32_dpp v68, v49, v48 row_shl:4 row_mask:0xf bank_mask:0xf
    v_add_f32_dpp v69, v53, v52 row_shl:4 row_mask:0xf bank_mask:0xf
    v_add_f32_dpp v70, v57, v56 row_shl:4 row_mask:0xf bank_mask:0xf
    v_add_f32_dpp v71, v61, v60 row_shl:4 row_mask:0xf bank_mask:0xf
    v_add_f32_dpp v34, v35, v34 row_shl:4 row_mask:0xf bank_mask:0xf
    v_add_f32_dpp v38, v39, v38 row_shl:4 row_mask:0xf bank_mask:0xf
    v_add_f32_dpp v42, v43, v42 row_shl:4 row_mask:0xf bank_mask:0xf
    v_add_f32_dpp v46, v47, v46 row_shl:4 row_mask:0xf bank_mask:0xf
    v_add_f32_dpp v50, v51, v50 row_shl:4 row_mask:0xf bank_mask:0xf
    v_add_f32_dpp v54, v55, v54 row_shl:4 row_mask:0xf bank_mask:0xf
    v_add_f32_dpp v58, v59, v58 row_shl:4 row_mask:0xf bank_mask:0xf
    v_add_f32_dpp v62, v63, v62 row_shl:4 row_mask:0xf bank_mask:0xf
    v_add_f32_dpp v64, v34, v64 row_shl:8 row_mask:0xf bank_mask:0xf
    v_add_f32_dpp v65, v38, v65 row_shl:8 row_mask:0xf bank_mask:0xf
    v_add_f32_dpp v66, v42, v66 row_shl:8 row_mask:0xf bank_mask:0xf
    v_add_f32_dpp v67, v46, v67 row_shl:8 row_mask:0xf bank_mask:0xf
    v_add_f32_dpp v68, v50, v68 row_shl:8 row_mask:0xf bank_mask:0xf
    v_add_f32_dpp v69, v54, v69 row_shl:8 row_mask:0xf bank_mask:0xf
    v_add_f32_dpp v70, v58, v70 row_shl:8 row_mask:0xf bank_mask:0xf
    v_add_f32_dpp v71, v62, v71 row_shl:8 row_mask:0xf bank_mask:0xf
    s_add_u32 s63, s62, 4096
    s_waitcnt vmcnt(5)
    buffer_load_dwordx4 v[184:187], v2, s[40:43], s63 offen offset:2048 nt
    s_add_u32 s63, s62, 4096
    s_waitcnt vmcnt(5)
    buffer_load_dwordx4 v[188:191], v2, s[40:43], s63 offen offset:3072 nt
    v_mfma_f32_16x16x32_bf16 v[32:35], v[96:99], v[28:31], 0
    v_mfma_f32_16x16x32_bf16 v[36:39], v[100:103], v[28:31], 0
    v_mfma_f32_16x16x32_bf16 v[40:43], v[104:107], v[28:31], 0
    v_mfma_f32_16x16x32_bf16 v[44:47], v[108:111], v[28:31], 0
    v_mfma_f32_16x16x32_bf16 v[48:51], v[112:115], v[28:31], 0
    v_mfma_f32_16x16x32_bf16 v[52:55], v[116:119], v[28:31], 0
    v_mfma_f32_16x16x32_bf16 v[56:59], v[120:123], v[28:31], 0
    v_mfma_f32_16x16x32_bf16 v[60:63], v[124:127], v[28:31], 0
    s_nop 0
    v_add_f32_dpp v72, v33, v32 row_shl:4 row_mask:0xf bank_mask:0xf
    v_add_f32_dpp v73, v37, v36 row_shl:4 row_mask:0xf bank_mask:0xf
    v_add_f32_dpp v74, v41, v40 row_shl:4 row_mask:0xf bank_mask:0xf
    v_add_f32_dpp v75, v45, v44 row_shl:4 row_mask:0xf bank_mask:0xf
    v_add_f32_dpp v76, v49, v48 row_shl:4 row_mask:0xf bank_mask:0xf
    v_add_f32_dpp v77, v53, v52 row_shl:4 row_mask:0xf bank_mask:0xf
    v_add_f32_dpp v78, v57, v56 row_shl:4 row_mask:0xf bank_mask:0xf
    v_add_f32_dpp v79, v61, v60 row_shl:4 row_mask:0xf bank_mask:0xf
    v_add_f32_dpp v34, v35, v34 row_shl:4 row_mask:0xf bank_mask:0xf
    v_add_f32_dpp v38, v39, v38 row_shl:4 row_mask:0xf bank_mask:0xf
    v_add_f32_dpp v42, v43, v42 row_shl:4 row_mask:0xf bank_mask:0xf
    v_add_f32_dpp v46, v47, v46 row_shl:4 row_mask:0xf bank_mask:0xf
    v_add_f32_dpp v50, v51, v50 row_shl:4 row_mask:0xf bank_mask:0xf
    v_add_f32_dpp v54, v55, v54 row_shl:4 row_mask:0xf bank_mask:0xf
    v_add_f32_dpp v58, v59, v58 row_shl:4 row_mask:0xf bank_mask:0xf
    v_add_f32_dpp v62, v63, v62 row_shl:4 row_mask:0xf bank_mask:0xf
    v_add_f32_dpp v72, v34, v72 row_shl:8 row_mask:0xf bank_mask:0xf
    v_add_f32_dpp v73, v38, v73 row_shl:8 row_mask:0xf bank_mask:0xf
    v_add_f32_dpp v74, v42, v74 row_shl:8 row_mask:0xf bank_mask:0xf
    v_add_f32_dpp v75, v46, v75 row_shl:8 row_mask:0xf bank_mask:0xf
    v_add_f32_dpp v76, v50, v76 row_shl:8 row_mask:0xf bank_mask:0xf
    v_add_f32_dpp v77, v54, v77 row_shl:8 row_mask:0xf bank_mask:0xf
    v_add_f32_dpp v78, v58, v78 row_shl:8 row_mask:0xf bank_mask:0xf
    v_add_f32_dpp v79, v62, v79 row_shl:8 row_mask:0xf bank_mask:0xf
    s_add_u32 s63, s62, 8192
    s_waitcnt vmcnt(5)
    buffer_load_dwordx4 v[192:195], v2, s[40:43], s63 offen offset:0 nt
    s_add_u32 s63, s62, 8192
    s_waitcnt vmcnt(5)
    buffer_load_dwordx4 v[196:199], v2, s[40:43], s63 offen offset:1024 nt
    v_mfma_f32_16x16x32_bf16 v[32:35], v[128:131], v[28:31], 0
    v_mfma_f32_16x16x32_bf16 v[36:39], v[132:135], v[28:31], 0
    v_mfma_f32_16x16x32_bf16 v[40:43], v[136:139], v[28:31], 0
    v_mfma_f32_16x16x32_bf16 v[44:47], v[140:143], v[28:31], 0
    v_mfma_f32_16x16x32_bf16 v[48:51], v[144:147], v[28:31], 0
    v_mfma_f32_16x16x32_bf16 v[52:55], v[148:151], v[28:31], 0
    v_mfma_f32_16x16x32_bf16 v[56:59], v[152:155], v[28:31], 0
    v_mfma_f32_16x16x32_bf16 v[60:63], v[156:159], v[28:31], 0
    s_nop 0
    v_add_f32_dpp v80, v33, v32 row_shl:4 row_mask:0xf bank_mask:0xf
    v_add_f32_dpp v81, v37, v36 row_shl:4 row_mask:0xf bank_mask:0xf
    v_add_f32_dpp v82, v41, v40 row_shl:4 row_mask:0xf bank_mask:0xf
    v_add_f32_dpp v83, v45, v44 row_shl:4 row_mask:0xf bank_mask:0xf
    v_add_f32_dpp v84, v49, v48 row_shl:4 row_mask:0xf bank_mask:0xf
    v_add_f32_dpp v85, v53, v52 row_shl:4 row_mask:0xf bank_mask:0xf
    v_add_f32_dpp v86, v57, v56 row_shl:4 row_mask:0xf bank_mask:0xf
    v_add_f32_dpp v87, v61, v60 row_shl:4 row_mask:0xf bank_mask:0xf
    v_add_f32_dpp v34, v35, v34 row_shl:4 row_mask:0xf bank_mask:0xf
    v_add_f32_dpp v38, v39, v38 row_shl:4 row_mask:0xf bank_mask:0xf
    v_add_f32_dpp v42, v43, v42 row_shl:4 row_mask:0xf bank_mask:0xf
    v_add_f32_dpp v46, v47, v46 row_shl:4 row_mask:0xf bank_mask:0xf
    v_add_f32_dpp v50, v51, v50 row_shl:4 row_mask:0xf bank_mask:0xf
    v_add_f32_dpp v54, v55, v54 row_shl:4 row_mask:0xf bank_mask:0xf
    v_add_f32_dpp v58, v59, v58 row_shl:4 row_mask:0xf bank_mask:0xf
    v_add_f32_dpp v62, v63, v62 row_shl:4 row_mask:0xf bank_mask:0xf
    v_add_f32_dpp v80, v34, v80 row_shl:8 row_mask:0xf bank_mask:0xf
    v_add_f32_dpp v81, v38, v81 row_shl:8 row_mask:0xf bank_mask:0xf
    v_add_f32_dpp v82, v42, v82 row_shl:8 row_mask:0xf bank_mask:0xf
    v_add_f32_dpp v83, v46, v83 row_shl:8 row_mask:0xf bank_mask:0xf
    v_add_f32_dpp v84, v50, v84 row_shl:8 row_mask:0xf bank_mask:0xf
    v_add_f32_dpp v85, v54, v85 row_shl:8 row_mask:0xf bank_mask:0xf
    v_add_f32_dpp v86, v58, v86 row_shl:8 row_mask:0xf bank_mask:0xf
    v_add_f32_dpp v87, v62, v87 row_shl:8 row_mask:0xf bank_mask:0xf
    s_add_u32 s63, s62, 8192
    s_waitcnt vmcnt(5)
    buffer_load_dwordx4 v[200:203], v2, s[40:43], s63 offen offset:2048 nt
    s_add_u32 s63, s62, 8192
    s_waitcnt vmcnt(5)
    buffer_load_dwordx4 v[204:207], v2, s[40:43], s63 offen offset:3072 nt
    v_max3_f32 v4, v64, v65, v66
    v_max3_f32 v4, v4, v67, v68
    v_max3_f32 v4, v4, v69, v70
    v_max3_f32 v4, v4, v71, v72
    v_max3_f32 v4, v4, v73, v74
    v_max3_f32 v4, v4, v75, v76
    v_max3_f32 v4, v4, v77, v78
    v_max3_f32 v4, v4, v79, v80
    v_max3_f32 v4, v4, v81, v82
    v_max3_f32 v4, v4, v83, v84
    v_max3_f32 v4, v4, v85, v86
    v_max_f32 v4, v4, v87
    v_mov_b32 v5, v4
    s_nop 1
    v_permlane16_swap_b32 v4, v5
    v_max_f32 v4, v4, v5
    v_mov_b32 v5, v4
    s_nop 1
    v_permlane32_swap_b32 v4, v5
    v_max_f32 v4, v4, v5
    v_mul_f32 v4, s82, v4
    s_mov_b64 exec, 0xf
    ds_write_b32 v6, v4 offset:1024
    s_mov_b64 exec, -1
    s_waitcnt lgkmcnt(0)
    s_add_u32 s63, s62, 12288
    s_waitcnt vmcnt(5)
    buffer_load_dwordx4 v[208:211], v2, s[40:43], s63 offen offset:0 nt
    s_add_u32 s63, s62, 12288
    s_waitcnt vmcnt(5)
    buffer_load_dwordx4 v[212:215], v2, s[40:43], s63 offen offset:1024 nt
    s_barrier
    ds_read_b128 v[8:11], v7 offset:1024
    ds_read_b128 v[12:15], v7 offset:1040
    s_waitcnt lgkmcnt(0)
    v_max3_f32 v8, v8, v9, v10
    v_max3_f32 v12, v11, v12, v13
    v_max3_f32 v8, v8, v14, v15
    v_max_f32 v16, v8, v12
    s_add_u32 s63, s62, 12288
    s_waitcnt vmcnt(5)
    buffer_load_dwordx4 v[216:219], v2, s[40:43], s63 offen offset:2048 nt
    s_add_u32 s63, s62, 12288
    s_waitcnt vmcnt(5)
    buffer_load_dwordx4 v[220:223], v2, s[40:43], s63 offen offset:3072 nt
    v_fma_f32 v64, v64, s82, -v16
    v_fma_f32 v65, v65, s82, -v16
    v_fma_f32 v66, v66, s82, -v16
    v_fma_f32 v67, v67, s82, -v16
    v_fma_f32 v68, v68, s82, -v16
    v_fma_f32 v69, v69, s82, -v16
    v_fma_f32 v70, v70, s82, -v16
    v_fma_f32 v71, v71, s82, -v16
    v_fma_f32 v72, v72, s82, -v16
    v_fma_f32 v73, v73, s82, -v16
    v_fma_f32 v74, v74, s82, -v16
    v_fma_f32 v75, v75, s82, -v16
    v_fma_f32 v76, v76, s82, -v16
    v_fma_f32 v77, v77, s82, -v16
    v_fma_f32 v78, v78, s82, -v16
    v_fma_f32 v79, v79, s82, -v16
    v_fma_f32 v80, v80, s82, -v16
    v_fma_f32 v81, v81, s82, -v16
    v_fma_f32 v82, v82, s82, -v16
    v_fma_f32 v83, v83, s82, -v16
    v_fma_f32 v84, v84, s82, -v16
    v_fma_f32 v85, v85, s82, -v16
    v_fma_f32 v86, v86, s82, -v16
    v_fma_f32 v87, v87, s82, -v16
    v_exp_f32 v64, v64
    v_exp_f32 v65, v65
    v_exp_f32 v66, v66
    v_exp_f32 v67, v67
    v_exp_f32 v68, v68
    v_exp_f32 v69, v69
    v_exp_f32 v70, v70
    v_exp_f32 v71, v71
    v_exp_f32 v72, v72
    v_exp_f32 v73, v73
    v_exp_f32 v74, v74
    v_exp_f32 v75, v75
    v_exp_f32 v76, v76
    v_exp_f32 v77, v77
    v_exp_f32 v78, v78
    v_exp_f32 v79, v79
    v_exp_f32 v80, v80
    v_exp_f32 v81, v81
    v_exp_f32 v82, v82
    v_exp_f32 v83, v83
    v_exp_f32 v84, v84
    v_exp_f32 v85, v85
    v_exp_f32 v86, v86
    v_exp_f32 v87, v87
    v_add_f32 v4, v64, v65
    v_add_f32 v5, v66, v67
    v_add_f32 v4, v4, v68
    v_add_f32 v5, v5, v69
    v_add_f32 v4, v4, v70
    v_add_f32 v5, v5, v71
    v_add_f32 v4, v4, v72
    v_add_f32 v5, v5, v73
    v_add_f32 v4, v4, v74
    v_add_f32 v5, v5, v75
    v_add_f32 v4, v4, v76
    v_add_f32 v5, v5, v77
    v_add_f32 v4, v4, v78
    v_add_f32 v5, v5, v79
    v_add_f32 v4, v4, v80
    v_add_f32 v5, v5, v81
    v_add_f32 v4, v4, v82
    v_add_f32 v5, v5, v83
    v_add_f32 v4, v4, v84
    v_add_f32 v5, v5, v85
    v_add_f32 v4, v4, v86
    v_add_f32 v5, v5, v87
    v_add_f32 v4, v4, v5
    v_cvt_pk_bf16_f32 v64, v64, v65
    v_cvt_pk_bf16_f32 v65, v66, v67
    v_cvt_pk_bf16_f32 v66, v68, v69
    v_cvt_pk_bf16_f32 v67, v70, v71
    v_cvt_pk_bf16_f32 v72, v72, v73
    v_cvt_pk_bf16_f32 v73, v74, v75
    v_cvt_pk_bf16_f32 v74, v76, v77
    v_cvt_pk_bf16_f32 v75, v78, v79
    v_cvt_pk_bf16_f32 v80, v80, v81
    v_cvt_pk_bf16_f32 v81, v82, v83
    v_cvt_pk_bf16_f32 v82, v84, v85
    v_cvt_pk_bf16_f32 v83, v86, v87
    v_mov_b32 v5, v4
    s_nop 1
    v_permlane16_swap_b32 v4, v5
    v_add_f32 v4, v4, v5
    v_mov_b32 v5, v4
    s_nop 1
    v_permlane32_swap_b32 v4, v5
    v_add_f32 v4, v4, v5
    s_mov_b64 exec, 0xf
    ds_write_b32 v6, v4 offset:1152
    s_mov_b64 exec, -1
    s_waitcnt lgkmcnt(0)
    s_add_u32 s63, s62, 16384
    s_waitcnt vmcnt(5)
    buffer_load_dwordx4 v[224:227], v2, s[40:43], s63 offen offset:0 nt
    s_add_u32 s63, s62, 16384
    s_waitcnt vmcnt(5)
    buffer_load_dwordx4 v[228:231], v2, s[40:43], s63 offen offset:1024 nt
    s_barrier
    v_perm_b32 v128, v164, v160, s80
    v_perm_b32 v132, v164, v160, s81
    v_perm_b32 v136, v165, v161, s80
    v_perm_b32 v140, v165, v161, s81
    v_perm_b32 v144, v166, v162, s80
    v_perm_b32 v148, v166, v162, s81
    v_perm_b32 v152, v167, v163, s80
    v_perm_b32 v156, v167, v163, s81
    v_perm_b32 v129, v172, v168, s80
    v_perm_b32 v133, v172, v168, s81
    v_perm_b32 v137, v173, v169, s80
    v_perm_b32 v141, v173, v169, s81
    v_perm_b32 v145, v174, v170, s80
    v_perm_b32 v149, v174, v170, s81
    v_perm_b32 v153, v175, v171, s80
    v_perm_b32 v157, v175, v171, s81
    v_perm_b32 v130, v180, v176, s80
    v_perm_b32 v134, v180, v176, s81
    v_perm_b32 v138, v181, v177, s80
    v_perm_b32 v142, v181, v177, s81
    v_perm_b32 v146, v182, v178, s80
    v_perm_b32 v150, v182, v178, s81
    v_perm_b32 v154, v183, v179, s80
    v_perm_b32 v158, v183, v179, s81
    v_perm_b32 v131, v188, v184, s80
    v_perm_b32 v135, v188, v184, s81
    v_perm_b32 v139, v189, v185, s80
    v_perm_b32 v143, v189, v185, s81
    v_perm_b32 v147, v190, v186, s80
    v_perm_b32 v151, v190, v186, s81
    v_perm_b32 v155, v191, v187, s80
    v_perm_b32 v159, v191, v187, s81
    v_mfma_f32_16x16x32_bf16 v[32:35], v[128:131], v[64:67], 0
    v_mfma_f32_16x16x32_bf16 v[36:39], v[132:135], v[64:67], 0
    v_mfma_f32_16x16x32_bf16 v[40:43], v[136:139], v[64:67], 0
    v_mfma_f32_16x16x32_bf16 v[44:47], v[140:143], v[64:67], 0
    v_mfma_f32_16x16x32_bf16 v[48:51], v[144:147], v[64:67], 0
    v_mfma_f32_16x16x32_bf16 v[52:55], v[148:151], v[64:67], 0
    v_mfma_f32_16x16x32_bf16 v[56:59], v[152:155], v[64:67], 0
    v_mfma_f32_16x16x32_bf16 v[60:63], v[156:159], v[64:67], 0
    s_add_u32 s63, s62, 16384
    s_waitcnt vmcnt(3)
    buffer_load_dwordx4 v[232:235], v2, s[40:43], s63 offen offset:2048 nt
    s_add_u32 s63, s62, 16384
    s_waitcnt vmcnt(3)
    buffer_load_dwordx4 v[236:239], v2, s[40:43], s63 offen offset:3072 nt
    s_add_u32 s63, s62, 20480
    s_waitcnt vmcnt(3)
    buffer_load_dwordx4 v[240:243], v2, s[40:43], s63 offen offset:0 nt
    s_add_u32 s63, s62, 20480
    s_waitcnt vmcnt(3)
    buffer_load_dwordx4 v[244:247], v2, s[40:43], s63 offen offset:1024 nt
    s_add_u32 s63, s62, 20480
    s_waitcnt vmcnt(3)
    buffer_load_dwordx4 v[248:251], v2, s[40:43], s63 offen offset:2048 nt
    s_add_u32 s63, s62, 20480
    s_waitcnt vmcnt(3)
    buffer_load_dwordx4 v[252:255], v2, s[40:43], s63 offen offset:3072 nt
    s_cmp_lt_u32 s33, 3
    s_cselect_b32 s3, 1, 0
    s_cmp_lt_u32 s32, 4
    s_cselect_b32 s3, s3, 0
    s_mov_b32 s44, s24
    s_mov_b32 s45, s25
    s_mov_b32 s46, 4194304
    s_mov_b32 s47, 0x20000
    s_cmp_eq_u32 s3, 1
    s_cselect_b32 s46, s46, 0
    s_and_b32 s87, s35, 3
    s_lshr_b32 s86, s35, 2
    s_lshl_b32 s60, s34, 2
    s_add_u32 s86, s86, s60
    v_and_b32 v20, 15, v0
    v_bfe_u32 v3, v0, 4, 1
    v_lshlrev_b32 v3, 16, v3
    v_lshrrev_b32 v21, 5, v0
    v_lshl_add_u32 v3, v21, 10, v3
    v_lshl_add_u32 v3, v20, 4, v3
    s_lshl_b32 s60, s86, 17
    s_lshl_b32 s61, s87, 11
    s_add_u32 s60, s60, s61
    s_lshl_b32 s61, s32, 8
    s_add_u32 s60, s60, s61
    s_add_u32 s63, s60, 0
    buffer_load_dwordx4 v[96:99], v3, s[44:47], s63 offen nt
    s_add_u32 s63, s60, 8192
    buffer_load_dwordx4 v[100:103], v3, s[44:47], s63 offen nt
    s_add_u32 s63, s60, 16384
    buffer_load_dwordx4 v[104:107], v3, s[44:47], s63 offen nt
    s_add_u32 s63, s60, 24576
    buffer_load_dwordx4 v[108:111], v3, s[44:47], s63 offen nt
    s_add_u32 s63, s60, 32768
    buffer_load_dwordx4 v[112:115], v3, s[44:47], s63 offen nt
    s_add_u32 s63, s60, 40960
    buffer_load_dwordx4 v[116:119], v3, s[44:47], s63 offen nt
    s_add_u32 s63, s60, 49152
    buffer_load_dwordx4 v[120:123], v3, s[44:47], s63 offen nt
    s_add_u32 s63, s60, 57344
    buffer_load_dwordx4 v[124:127], v3, s[44:47], s63 offen nt
    s_mov_b64 exec, 1
    ds_add_u32 v18, v19 offset:1284
    s_mov_b64 exec, -1
    v_perm_b32 v128, v196, v192, s80
    v_perm_b32 v132, v196, v192, s81
    v_perm_b32 v136, v197, v193, s80
    v_perm_b32 v140, v197, v193, s81
    v_perm_b32 v144, v198, v194, s80
    v_perm_b32 v148, v198, v194, s81
    v_perm_b32 v152, v199, v195, s80
    v_perm_b32 v156, v199, v195, s81
    v_perm_b32 v129, v204, v200, s80
    v_perm_b32 v133, v204, v200, s81
    v_perm_b32 v137, v205, v201, s80
    v_perm_b32 v141, v205, v201, s81
    v_perm_b32 v145, v206, v202, s80
    v_perm_b32 v149, v206, v202, s81
    v_perm_b32 v153, v207, v203, s80
    v_perm_b32 v157, v207, v203, s81
    v_perm_b32 v130, v212, v208, s80
    v_perm_b32 v134, v212, v208, s81
    v_perm_b32 v138, v213, v209, s80
    v_perm_b32 v142, v213, v209, s81
    v_perm_b32 v146, v214, v210, s80
    v_perm_b32 v150, v214, v210, s81
    v_perm_b32 v154, v215, v211, s80
    v_perm_b32 v158, v215, v211, s81
    v_perm_b32 v131, v220, v216, s80
    v_perm_b32 v135, v220, v216, s81
    v_perm_b32 v139, v221, v217, s80
    v_perm_b32 v143, v221, v217, s81
    v_perm_b32 v147, v222, v218, s80
    v_perm_b32 v151, v222, v218, s81
    v_perm_b32 v155, v223, v219, s80
    v_perm_b32 v159, v223, v219, s81
    v_mfma_f32_16x16x32_bf16 v[32:35], v[128:131], v[72:75], v[32:35]
    v_mfma_f32_16x16x32_bf16 v[36:39], v[132:135], v[72:75], v[36:39]
    v_mfma_f32_16x16x32_bf16 v[40:43], v[136:139], v[72:75], v[40:43]
    v_mfma_f32_16x16x32_bf16 v[44:47], v[140:143], v[72:75], v[44:47]
    v_mfma_f32_16x16x32_bf16 v[48:51], v[144:147], v[72:75], v[48:51]
    v_mfma_f32_16x16x32_bf16 v[52:55], v[148:151], v[72:75], v[52:55]
    v_mfma_f32_16x16x32_bf16 v[56:59], v[152:155], v[72:75], v[56:59]
    v_mfma_f32_16x16x32_bf16 v[60:63], v[156:159], v[72:75], v[60:63]
    s_and_b32 s60, s32, 1
    s_lshl_b32 s60, s60, 1
    v_lshrrev_b32 v4, 5, v0
    v_add_u32 v4, s60, v4
    v_and_b32 v5, 31, v0
    v_lshlrev_b32 v5, 4, v5
    v_mul_u32_u24 v8, 528, v4
    v_add_u32 v8, v8, v5
    v_mul_u32_u24 v4, 12288, v4
    v_add_u32 v4, v4, v5
    s_mul_i32 s60, s34, 49152
    s_lshl_b32 s61, s35, 9
    s_add_u32 s60, s60, s61
    s_add_u32 s60, s60, 196608
    s_add_u32 s59, s60, 1048576
    v_perm_b32 v128, v228, v224, s80
    v_perm_b32 v132, v228, v224, s81
    v_perm_b32 v136, v229, v225, s80
    v_perm_b32 v140, v229, v225, s81
    v_perm_b32 v144, v230, v226, s80
    v_perm_b32 v148, v230, v226, s81
    v_perm_b32 v152, v231, v227, s80
    v_perm_b32 v156, v231, v227, s81
    v_perm_b32 v129, v236, v232, s80
    v_perm_b32 v133, v236, v232, s81
    v_perm_b32 v137, v237, v233, s80
    v_perm_b32 v141, v237, v233, s81
    v_perm_b32 v145, v238, v234, s80
    v_perm_b32 v149, v238, v234, s81
    v_perm_b32 v153, v239, v235, s80
    v_perm_b32 v157, v239, v235, s81
    s_waitcnt vmcnt(10)
    v_perm_b32 v130, v244, v240, s80
    v_perm_b32 v134, v244, v240, s81
    v_perm_b32 v138, v245, v241, s80
    v_perm_b32 v142, v245, v241, s81
    v_perm_b32 v146, v246, v242, s80
    v_perm_b32 v150, v246, v242, s81
    v_perm_b32 v154, v247, v243, s80
    v_perm_b32 v158, v247, v243, s81
    s_waitcnt vmcnt(8)
    v_perm_b32 v131, v252, v248, s80
    v_perm_b32 v135, v252, v248, s81
    v_perm_b32 v139, v253, v249, s80
    v_perm_b32 v143, v253, v249, s81
    v_perm_b32 v147, v254, v250, s80
    v_perm_b32 v151, v254, v250, s81
    v_perm_b32 v155, v255, v251, s80
    v_perm_b32 v159, v255, v251, s81
    v_mfma_f32_16x16x32_bf16 v[32:35], v[128:131], v[80:83], v[32:35]
    v_mfma_f32_16x16x32_bf16 v[36:39], v[132:135], v[80:83], v[36:39]
    v_mfma_f32_16x16x32_bf16 v[40:43], v[136:139], v[80:83], v[40:43]
    v_mfma_f32_16x16x32_bf16 v[44:47], v[140:143], v[80:83], v[44:47]
    v_mfma_f32_16x16x32_bf16 v[48:51], v[144:147], v[80:83], v[48:51]
    v_mfma_f32_16x16x32_bf16 v[52:55], v[148:151], v[80:83], v[52:55]
    v_mfma_f32_16x16x32_bf16 v[56:59], v[152:155], v[80:83], v[56:59]
    v_mfma_f32_16x16x32_bf16 v[60:63], v[156:159], v[80:83], v[60:63]
    s_mov_b32 exec_lo, 0x000f000f
    s_mov_b32 exec_hi, 0x000f000f
    ds_write_b128 v17, v[32:35] offset:2048
    ds_write_b128 v17, v[36:39] offset:2112
    ds_write_b128 v17, v[40:43] offset:2176
    ds_write_b128 v17, v[44:47] offset:2240
    ds_write_b128 v17, v[48:51] offset:2304
    ds_write_b128 v17, v[52:55] offset:2368
    ds_write_b128 v17, v[56:59] offset:2432
    ds_write_b128 v17, v[60:63] offset:2496
    s_mov_b64 exec, 1
    ds_add_u32 v18, v19 offset:1280
    s_mov_b64 exec, -1
    s_cmp_eq_u32 s3, 1
    s_cbranch_scc1 L_B_co
    s_and_b32 s61, s32, 6
    s_cmp_eq_u32 s61, 4
    s_cbranch_scc0 L_fin
L_B_red:
    s_waitcnt lgkmcnt(6)
    ds_read_b32 v9, v18 offset:1280
    ds_read_b128 v[64:67], v8 offset:2048
    ds_read_b128 v[68:71], v8 offset:4160
    ds_read_b128 v[72:75], v8 offset:6272
    ds_read_b128 v[76:79], v8 offset:8384
    ds_read_b128 v[80:83], v8 offset:10496
    ds_read_b128 v[84:87], v8 offset:12608
    ds_read_b128 v[88:91], v8 offset:14720
    ds_read_b128 v[92:95], v8 offset:16832
    s_waitcnt lgkmcnt(8)
    v_cmp_ne_u32 vcc, 8, v9
    s_nop 3
    s_cbranch_vccnz L_B_red
    s_waitcnt lgkmcnt(6)
    v_pk_add_f32 v[64:65], v[64:65], v[68:69]
    v_pk_add_f32 v[66:67], v[66:67], v[70:71]
    s_waitcnt lgkmcnt(5)
    v_pk_add_f32 v[64:65], v[64:65], v[72:73]
    v_pk_add_f32 v[66:67], v[66:67], v[74:75]
    s_waitcnt lgkmcnt(4)
    v_pk_add_f32 v[64:65], v[64:65], v[76:77]
    v_pk_add_f32 v[66:67], v[66:67], v[78:79]
    s_waitcnt lgkmcnt(3)
    v_pk_add_f32 v[64:65], v[64:65], v[80:81]
    v_pk_add_f32 v[66:67], v[66:67], v[82:83]
    s_waitcnt lgkmcnt(2)
    v_pk_add_f32 v[64:65], v[64:65], v[84:85]
    v_pk_add_f32 v[66:67], v[66:67], v[86:87]
    s_waitcnt lgkmcnt(1)
    v_pk_add_f32 v[64:65], v[64:65], v[88:89]
    v_pk_add_f32 v[66:67], v[66:67], v[90:91]
    s_waitcnt lgkmcnt(0)
    v_pk_add_f32 v[64:65], v[64:65], v[92:93]
    v_pk_add_f32 v[66:67], v[66:67], v[94:95]
    v_and_or_b32 v64, v64, v23, s72
    v_and_or_b32 v65, v65, v23, s73
    v_and_or_b32 v66, v66, v23, s74
    v_and_or_b32 v67, v67, v23, s75
    buffer_store_dwordx4 v[64:67], v4, s[48:51], s59 offen
    buffer_store_dwordx4 v[64:67], v4, s[48:51], s60 offen sc1
    s_nop 0
    s_branch L_fin
L_B_co:
    s_waitcnt vmcnt(6)
    v_perm_b32 v160, v100, v96, s80
    v_perm_b32 v164, v100, v96, s81
    v_perm_b32 v168, v101, v97, s80
    v_perm_b32 v172, v101, v97, s81
    v_perm_b32 v176, v102, v98, s80
    v_perm_b32 v180, v102, v98, s81
    v_perm_b32 v184, v103, v99, s80
    v_perm_b32 v188, v103, v99, s81
    s_waitcnt vmcnt(4)
    v_perm_b32 v161, v108, v104, s80
    v_perm_b32 v165, v108, v104, s81
    v_perm_b32 v169, v109, v105, s80
    v_perm_b32 v173, v109, v105, s81
    v_perm_b32 v177, v110, v106, s80
    v_perm_b32 v181, v110, v106, s81
    v_perm_b32 v185, v111, v107, s80
    v_perm_b32 v189, v111, v107, s81
    s_waitcnt vmcnt(2)
    v_perm_b32 v162, v116, v112, s80
    v_perm_b32 v166, v116, v112, s81
    v_perm_b32 v170, v117, v113, s80
    v_perm_b32 v174, v117, v113, s81
    v_perm_b32 v178, v118, v114, s80
    v_perm_b32 v182, v118, v114, s81
    v_perm_b32 v186, v119, v115, s80
    v_perm_b32 v190, v119, v115, s81
    s_waitcnt vmcnt(0)
    v_perm_b32 v163, v124, v120, s80
    v_perm_b32 v167, v124, v120, s81
    v_perm_b32 v171, v125, v121, s80
    v_perm_b32 v175, v125, v121, s81
    v_perm_b32 v179, v126, v122, s80
    v_perm_b32 v183, v126, v122, s81
    v_perm_b32 v187, v127, v123, s80
    v_perm_b32 v191, v127, v123, s81
    s_lshl_b32 s62, s86, 2
    s_add_u32 s62, s62, s87
    s_lshl_b32 s62, s62, 11
    s_lshl_b32 s63, s32, 9
    s_add_u32 s62, s62, s63
    s_add_u32 s62, s62, 589824
    v_lshrrev_b32 v5, 4, v0
    v_lshlrev_b32 v9, 5, v20
    v_lshl_add_u32 v9, v5, 4, v9
    v_lshlrev_b32 v5, 4, v5
    s_barrier
    ds_read_b128 v[64:67], v5
    s_waitcnt lgkmcnt(0)
    v_mfma_f32_16x16x32_bf16 v[32:35], v[64:67], v[160:163], 0
    v_mfma_f32_16x16x32_bf16 v[36:39], v[64:67], v[164:167], 0
    v_mfma_f32_16x16x32_bf16 v[40:43], v[64:67], v[168:171], 0
    v_mfma_f32_16x16x32_bf16 v[44:47], v[64:67], v[172:175], 0
    v_mfma_f32_16x16x32_bf16 v[48:51], v[64:67], v[176:179], 0
    v_mfma_f32_16x16x32_bf16 v[52:55], v[64:67], v[180:183], 0
    v_mfma_f32_16x16x32_bf16 v[56:59], v[64:67], v[184:187], 0
    v_mfma_f32_16x16x32_bf16 v[60:63], v[64:67], v[188:191], 0
    s_nop 4
    v_cndmask_b32 v12, v32, v48, s[88:89]
    v_cndmask_b32 v13, v36, v52, s[88:89]
    v_cndmask_b32 v14, v40, v56, s[88:89]
    v_cndmask_b32 v15, v44, v60, s[88:89]
    v_and_or_b32 v12, v12, v23, s72
    v_and_or_b32 v13, v13, v23, s73
    v_and_or_b32 v14, v14, v23, s74
    v_and_or_b32 v15, v15, v23, s75
    s_mov_b32 exec_hi, 0
    buffer_store_dwordx4 v[12:15], v9, s[48:51], s62 offen sc1
    s_mov_b64 exec, -1
    s_branch L_fin
L_B7X:
    s_load_dword s84, s[30:31], 155776
    s_mov_b32 s48, s30
    s_mov_b32 s49, s31
    s_mov_b32 s50, 8388608
    s_mov_b32 s51, 0x20000
    s_mov_b32 s44, s22
    s_mov_b32 s45, s23
    s_mov_b32 s46, 4194304
    s_mov_b32 s47, 0x20000
    s_mov_b32 s52, s16
    s_mov_b32 s53, s17
    s_mov_b32 s54, 1024
    s_mov_b32 s55, 0x20000
    s_and_b32 s87, s35, 3
    s_lshr_b32 s86, s35, 2
    s_lshl_b32 s60, s34, 2
    s_add_u32 s86, s86, s60
    v_lshrrev_b32 v3, 4, v0
    v_and_b32 v4, 15, v0
    v_lshlrev_b32 v5, 16, v3
    v_lshl_add_u32 v5, v4, 4, v5
    v_lshlrev_b32 v8, 4, v3
    s_lshl_b32 s60, s87, 8
    buffer_load_dwordx4 v[224:227], v8, s[52:55], s60 offen offset:0
    buffer_load_dwordx4 v[228:231], v8, s[52:55], s60 offen offset:64
    buffer_load_dwordx4 v[232:235], v8, s[52:55], s60 offen offset:128
    buffer_load_dwordx4 v[236:239], v8, s[52:55], s60 offen offset:192
    s_lshl_b32 s60, s87, 20
    s_lshl_b32 s61, s86, 8
    s_add_u32 s60, s60, s61
    s_add_u32 s63, s60, 0
    buffer_load_dwordx4 v[64:67], v5, s[44:47], s63 offen nt
    s_add_u32 s63, s60, 8192
    buffer_load_dwordx4 v[68:71], v5, s[44:47], s63 offen nt
    s_add_u32 s63, s60, 16384
    buffer_load_dwordx4 v[72:75], v5, s[44:47], s63 offen nt
    s_add_u32 s63, s60, 24576
    buffer_load_dwordx4 v[76:79], v5, s[44:47], s63 offen nt
    s_add_u32 s63, s60, 32768
    buffer_load_dwordx4 v[80:83], v5, s[44:47], s63 offen nt
    s_add_u32 s63, s60, 40960
    buffer_load_dwordx4 v[84:87], v5, s[44:47], s63 offen nt
    s_add_u32 s63, s60, 49152
    buffer_load_dwordx4 v[88:91], v5, s[44:47], s63 offen nt
    s_add_u32 s63, s60, 57344
    buffer_load_dwordx4 v[92:95], v5, s[44:47], s63 offen nt
    s_add_u32 s63, s60, 262144
    buffer_load_dwordx4 v[96:99], v5, s[44:47], s63 offen nt
    s_add_u32 s63, s60, 270336
    buffer_load_dwordx4 v[100:103], v5, s[44:47], s63 offen nt
    s_add_u32 s63, s60, 278528
    buffer_load_dwordx4 v[104:107], v5, s[44:47], s63 offen nt
    s_add_u32 s63, s60, 286720
    buffer_load_dwordx4 v[108:111], v5, s[44:47], s63 offen nt
    s_add_u32 s63, s60, 294912
    buffer_load_dwordx4 v[112:115], v5, s[44:47], s63 offen nt
    s_add_u32 s63, s60, 303104
    buffer_load_dwordx4 v[116:119], v5, s[44:47], s63 offen nt
    s_add_u32 s63, s60, 311296
    buffer_load_dwordx4 v[120:123], v5, s[44:47], s63 offen nt
    s_add_u32 s63, s60, 319488
    buffer_load_dwordx4 v[124:127], v5, s[44:47], s63 offen nt
    s_add_u32 s63, s60, 524288
    buffer_load_dwordx4 v[128:131], v5, s[44:47], s63 offen nt
    s_add_u32 s63, s60, 532480
    buffer_load_dwordx4 v[132:135], v5, s[44:47], s63 offen nt
    s_add_u32 s63, s60, 540672
    buffer_load_dwordx4 v[136:139], v5, s[44:47], s63 offen nt
    s_add_u32 s63, s60, 548864
    buffer_load_dwordx4 v[140:143], v5, s[44:47], s63 offen nt
    s_add_u32 s63, s60, 557056
    buffer_load_dwordx4 v[144:147], v5, s[44:47], s63 offen nt
    s_add_u32 s63, s60, 565248
    buffer_load_dwordx4 v[148:151], v5, s[44:47], s63 offen nt
    s_add_u32 s63, s60, 573440
    buffer_load_dwordx4 v[152:155], v5, s[44:47], s63 offen nt
    s_add_u32 s63, s60, 581632
    buffer_load_dwordx4 v[156:159], v5, s[44:47], s63 offen nt
    s_add_u32 s63, s60, 786432
    buffer_load_dwordx4 v[160:163], v5, s[44:47], s63 offen nt
    s_add_u32 s63, s60, 794624
    buffer_load_dwordx4 v[164:167], v5, s[44:47], s63 offen nt
    s_add_u32 s63, s60, 802816
    buffer_load_dwordx4 v[168:171], v5, s[44:47], s63 offen nt
    s_add_u32 s63, s60, 811008
    buffer_load_dwordx4 v[172:175], v5, s[44:47], s63 offen nt
    s_add_u32 s63, s60, 819200
    buffer_load_dwordx4 v[176:179], v5, s[44:47], s63 offen nt
    s_add_u32 s63, s60, 827392
    buffer_load_dwordx4 v[180:183], v5, s[44:47], s63 offen nt
    s_add_u32 s63, s60, 835584
    buffer_load_dwordx4 v[184:187], v5, s[44:47], s63 offen nt
    s_add_u32 s63, s60, 843776
    buffer_load_dwordx4 v[188:191], v5, s[44:47], s63 offen nt
    s_waitcnt lgkmcnt(0)
    s_add_u32 s84, s84, 0x9e3779b9
    s_mov_b32 s85, s84
    s_waitcnt vmcnt(30)
    v_perm_b32 v192, v68, v64, s80
    v_perm_b32 v196, v68, v64, s81
    v_perm_b32 v200, v69, v65, s80
    v_perm_b32 v204, v69, v65, s81
    v_perm_b32 v208, v70, v66, s80
    v_perm_b32 v212, v70, v66, s81
    v_perm_b32 v216, v71, v67, s80
    v_perm_b32 v220, v71, v67, s81
    s_waitcnt vmcnt(28)
    v_perm_b32 v193, v76, v72, s80
    v_perm_b32 v197, v76, v72, s81
    v_perm_b32 v201, v77, v73, s80
    v_perm_b32 v205, v77, v73, s81
    v_perm_b32 v209, v78, v74, s80
    v_perm_b32 v213, v78, v74, s81
    v_perm_b32 v217, v79, v75, s80
    v_perm_b32 v221, v79, v75, s81
    s_waitcnt vmcnt(26)
    v_perm_b32 v194, v84, v80, s80
    v_perm_b32 v198, v84, v80, s81
    v_perm_b32 v202, v85, v81, s80
    v_perm_b32 v206, v85, v81, s81
    v_perm_b32 v210, v86, v82, s80
    v_perm_b32 v214, v86, v82, s81
    v_perm_b32 v218, v87, v83, s80
    v_perm_b32 v222, v87, v83, s81
    s_waitcnt vmcnt(24)
    v_perm_b32 v195, v92, v88, s80
    v_perm_b32 v199, v92, v88, s81
    v_perm_b32 v203, v93, v89, s80
    v_perm_b32 v207, v93, v89, s81
    v_perm_b32 v211, v94, v90, s80
    v_perm_b32 v215, v94, v90, s81
    v_perm_b32 v219, v95, v91, s80
    v_perm_b32 v223, v95, v91, s81
    v_mfma_f32_16x16x32_bf16 v[32:35], v[224:227], v[192:195], 0
    v_mfma_f32_16x16x32_bf16 v[36:39], v[224:227], v[196:199], 0
    v_mfma_f32_16x16x32_bf16 v[40:43], v[224:227], v[200:203], 0
    v_mfma_f32_16x16x32_bf16 v[44:47], v[224:227], v[204:207], 0
    v_mfma_f32_16x16x32_bf16 v[48:51], v[224:227], v[208:211], 0
    v_mfma_f32_16x16x32_bf16 v[52:55], v[224:227], v[212:215], 0
    v_mfma_f32_16x16x32_bf16 v[56:59], v[224:227], v[216:219], 0
    v_mfma_f32_16x16x32_bf16 v[60:63], v[224:227], v[220:223], 0
    s_waitcnt vmcnt(22)
    v_perm_b32 v192, v100, v96, s80
    v_perm_b32 v196, v100, v96, s81
    v_perm_b32 v200, v101, v97, s80
    v_perm_b32 v204, v101, v97, s81
    v_perm_b32 v208, v102, v98, s80
    v_perm_b32 v212, v102, v98, s81
    v_perm_b32 v216, v103, v99, s80
    v_perm_b32 v220, v103, v99, s81
    s_waitcnt vmcnt(20)
    v_perm_b32 v193, v108, v104, s80
    v_perm_b32 v197, v108, v104, s81
    v_perm_b32 v201, v109, v105, s80
    v_perm_b32 v205, v109, v105, s81
    v_perm_b32 v209, v110, v106, s80
    v_perm_b32 v213, v110, v106, s81
    v_perm_b32 v217, v111, v107, s80
    v_perm_b32 v221, v111, v107, s81
    s_waitcnt vmcnt(18)
    v_perm_b32 v194, v116, v112, s80
    v_perm_b32 v198, v116, v112, s81
    v_perm_b32 v202, v117, v113, s80
    v_perm_b32 v206, v117, v113, s81
    v_perm_b32 v210, v118, v114, s80
    v_perm_b32 v214, v118, v114, s81
    v_perm_b32 v218, v119, v115, s80
    v_perm_b32 v222, v119, v115, s81
    s_waitcnt vmcnt(16)
    v_perm_b32 v195, v124, v120, s80
    v_perm_b32 v199, v124, v120, s81
    v_perm_b32 v203, v125, v121, s80
    v_perm_b32 v207, v125, v121, s81
    v_perm_b32 v211, v126, v122, s80
    v_perm_b32 v215, v126, v122, s81
    v_perm_b32 v219, v127, v123, s80
    v_perm_b32 v223, v127, v123, s81
    v_mfma_f32_16x16x32_bf16 v[32:35], v[228:231], v[192:195], v[32:35]
    v_mfma_f32_16x16x32_bf16 v[36:39], v[228:231], v[196:199], v[36:39]
    v_mfma_f32_16x16x32_bf16 v[40:43], v[228:231], v[200:203], v[40:43]
    v_mfma_f32_16x16x32_bf16 v[44:47], v[228:231], v[204:207], v[44:47]
    v_mfma_f32_16x16x32_bf16 v[48:51], v[228:231], v[208:211], v[48:51]
    v_mfma_f32_16x16x32_bf16 v[52:55], v[228:231], v[212:215], v[52:55]
    v_mfma_f32_16x16x32_bf16 v[56:59], v[228:231], v[216:219], v[56:59]
    v_mfma_f32_16x16x32_bf16 v[60:63], v[228:231], v[220:223], v[60:63]
    s_waitcnt vmcnt(14)
    v_perm_b32 v192, v132, v128, s80
    v_perm_b32 v196, v132, v128, s81
    v_perm_b32 v200, v133, v129, s80
    v_perm_b32 v204, v133, v129, s81
    v_perm_b32 v208, v134, v130, s80
    v_perm_b32 v212, v134, v130, s81
    v_perm_b32 v216, v135, v131, s80
    v_perm_b32 v220, v135, v131, s81
    s_waitcnt vmcnt(12)
    v_perm_b32 v193, v140, v136, s80
    v_perm_b32 v197, v140, v136, s81
    v_perm_b32 v201, v141, v137, s80
    v_perm_b32 v205, v141, v137, s81
    v_perm_b32 v209, v142, v138, s80
    v_perm_b32 v213, v142, v138, s81
    v_perm_b32 v217, v143, v139, s80
    v_perm_b32 v221, v143, v139, s81
    s_waitcnt vmcnt(10)
    v_perm_b32 v194, v148, v144, s80
    v_perm_b32 v198, v148, v144, s81
    v_perm_b32 v202, v149, v145, s80
    v_perm_b32 v206, v149, v145, s81
    v_perm_b32 v210, v150, v146, s80
    v_perm_b32 v214, v150, v146, s81
    v_perm_b32 v218, v151, v147, s80
    v_perm_b32 v222, v151, v147, s81
    s_waitcnt vmcnt(8)
    v_perm_b32 v195, v156, v152, s80
    v_perm_b32 v199, v156, v152, s81
    v_perm_b32 v203, v157, v153, s80
    v_perm_b32 v207, v157, v153, s81
    v_perm_b32 v211, v158, v154, s80
    v_perm_b32 v215, v158, v154, s81
    v_perm_b32 v219, v159, v155, s80
    v_perm_b32 v223, v159, v155, s81
    v_mfma_f32_16x16x32_bf16 v[32:35], v[232:235], v[192:195], v[32:35]
    v_mfma_f32_16x16x32_bf16 v[36:39], v[232:235], v[196:199], v[36:39]
    v_mfma_f32_16x16x32_bf16 v[40:43], v[232:235], v[200:203], v[40:43]
    v_mfma_f32_16x16x32_bf16 v[44:47], v[232:235], v[204:207], v[44:47]
    v_mfma_f32_16x16x32_bf16 v[48:51], v[232:235], v[208:211], v[48:51]
    v_mfma_f32_16x16x32_bf16 v[52:55], v[232:235], v[212:215], v[52:55]
    v_mfma_f32_16x16x32_bf16 v[56:59], v[232:235], v[216:219], v[56:59]
    v_mfma_f32_16x16x32_bf16 v[60:63], v[232:235], v[220:223], v[60:63]
    s_waitcnt vmcnt(6)
    v_perm_b32 v192, v164, v160, s80
    v_perm_b32 v196, v164, v160, s81
    v_perm_b32 v200, v165, v161, s80
    v_perm_b32 v204, v165, v161, s81
    v_perm_b32 v208, v166, v162, s80
    v_perm_b32 v212, v166, v162, s81
    v_perm_b32 v216, v167, v163, s80
    v_perm_b32 v220, v167, v163, s81
    s_waitcnt vmcnt(4)
    v_perm_b32 v193, v172, v168, s80
    v_perm_b32 v197, v172, v168, s81
    v_perm_b32 v201, v173, v169, s80
    v_perm_b32 v205, v173, v169, s81
    v_perm_b32 v209, v174, v170, s80
    v_perm_b32 v213, v174, v170, s81
    v_perm_b32 v217, v175, v171, s80
    v_perm_b32 v221, v175, v171, s81
    s_waitcnt vmcnt(2)
    v_perm_b32 v194, v180, v176, s80
    v_perm_b32 v198, v180, v176, s81
    v_perm_b32 v202, v181, v177, s80
    v_perm_b32 v206, v181, v177, s81
    v_perm_b32 v210, v182, v178, s80
    v_perm_b32 v214, v182, v178, s81
    v_perm_b32 v218, v183, v179, s80
    v_perm_b32 v222, v183, v179, s81
    s_waitcnt vmcnt(0)
    v_perm_b32 v195, v188, v184, s80
    v_perm_b32 v199, v188, v184, s81
    v_perm_b32 v203, v189, v185, s80
    v_perm_b32 v207, v189, v185, s81
    v_perm_b32 v211, v190, v186, s80
    v_perm_b32 v215, v190, v186, s81
    v_perm_b32 v219, v191, v187, s80
    v_perm_b32 v223, v191, v187, s81
    v_mfma_f32_16x16x32_bf16 v[32:35], v[236:239], v[192:195], v[32:35]
    v_mfma_f32_16x16x32_bf16 v[36:39], v[236:239], v[196:199], v[36:39]
    v_mfma_f32_16x16x32_bf16 v[40:43], v[236:239], v[200:203], v[40:43]
    v_mfma_f32_16x16x32_bf16 v[44:47], v[236:239], v[204:207], v[44:47]
    v_mfma_f32_16x16x32_bf16 v[48:51], v[236:239], v[208:211], v[48:51]
    v_mfma_f32_16x16x32_bf16 v[52:55], v[236:239], v[212:215], v[52:55]
    v_mfma_f32_16x16x32_bf16 v[56:59], v[236:239], v[216:219], v[56:59]
    v_mfma_f32_16x16x32_bf16 v[60:63], v[236:239], v[220:223], v[60:63]
    s_lshl_b32 s60, s86, 11
    s_lshl_b32 s61, s87, 9
    s_add_u32 s61, s60, s61
    s_add_u32 s61, s61, 0
    v_lshlrev_b32 v9, 5, v4
    v_lshl_add_u32 v9, v3, 4, v9
    v_cndmask_b32 v12, v32, v48, s[88:89]
    v_cndmask_b32 v13, v36, v52, s[88:89]
    v_cndmask_b32 v14, v40, v56, s[88:89]
    v_cndmask_b32 v15, v44, v60, s[88:89]
    s_mov_b32 exec_hi, 0
    buffer_store_dwordx4 v[12:15], v9, s[48:51], s61 offen sc1
    s_mov_b64 exec, -1
    s_lshl_b32 s60, s34, 9
    s_lshl_b32 s61, s35, 2
    s_add_u32 s60, s60, s61
    s_add_u32 s60, s60, 1114112
    s_waitcnt vmcnt(0)
    v_mov_b32 v20, s84
    v_lshlrev_b32 v21, 7, v0
    s_mov_b64 exec, 0xf
    buffer_store_dword v20, v21, s[48:51], s60 offen sc1
    s_mov_b64 exec, -1
    s_branch L_B7C
L_B7Y:
    ds_read_b128 v[64:67], v2 offset:36864
    s_and_b32 s3, s87, 1
    s_lshl_b32 s3, s3, 15
    s_lshr_b32 s63, s87, 1
    s_lshl_b32 s63, s63, 10
    s_add_u32 s3, s3, s63
    s_add_u32 s3, s3, 65536
    s_lshl_b32 s60, s87, 2
    s_add_u32 s60, s60, 1179648
    s_waitcnt lgkmcnt(0)
    s_add_u32 s84, s84, 0x9e3779b9
    s_mov_b32 s85, s84
    buffer_store_dwordx4 v[64:67], v2, s[48:51], s3 offen sc1
    s_waitcnt vmcnt(0)
    v_mov_b32 v20, s84
    v_lshlrev_b32 v21, 8, v0
    s_mov_b64 exec, 0xff
    buffer_store_dword v20, v21, s[48:51], s60 offen sc1
    s_mov_b64 exec, -1
    s_barrier
    s_load_dword s84, s[30:31], 155776
    s_waitcnt lgkmcnt(0)
    s_add_u32 s84, s84, 0x9e3779b9
    s_mov_b32 s85, s84
L_B7C:
    v_and_b32 v7, 3, v0
    v_lshlrev_b32 v7, 5, v7
    s_lshl_b32 s60, s32, 2
    v_add_u32 v6, s60, v7
    v_and_b32 v17, 3, v0
    v_mul_u32_u24 v17, 528, v17
    v_lshrrev_b32 v3, 4, v0
    v_lshl_add_u32 v17, v3, 4, v17
    s_mul_i32 s60, s32, 2112
    v_add_u32 v17, s60, v17
    v_mov_b32 v18, 0
    v_mov_b32 v19, 1
    s_cmp_eq_u32 s33, 3
    s_cbranch_scc0 L_B7N
    s_add_u32 s63, s62, 0
    buffer_load_dwordx4 v[64:67], v1, s[36:39], s63 offen offset:0 nt
    buffer_load_dwordx4 v[68:71], v1, s[36:39], s63 offen offset:1024 nt
    buffer_load_dwordx4 v[72:75], v1, s[36:39], s63 offen offset:2048 nt
    buffer_load_dwordx4 v[76:79], v1, s[36:39], s63 offen offset:3072 nt
    s_add_u32 s63, s62, 4096
    s_waitcnt vmcnt(3)
    buffer_load_dwordx4 v[80:83], v1, s[36:39], s63 offen offset:0 nt
    s_waitcnt vmcnt(3)
    buffer_load_dwordx4 v[84:87], v1, s[36:39], s63 offen offset:1024 nt
    s_waitcnt vmcnt(3)
    buffer_load_dwordx4 v[88:91], v1, s[36:39], s63 offen offset:2048 nt
    s_waitcnt vmcnt(3)
    buffer_load_dwordx4 v[92:95], v1, s[36:39], s63 offen offset:3072 nt
    s_add_u32 s63, s62, 0
    s_waitcnt vmcnt(3)
    buffer_load_dwordx4 v[160:163], v2, s[40:43], s63 offen offset:0 nt
    s_waitcnt vmcnt(3)
    buffer_load_dwordx4 v[164:167], v2, s[40:43], s63 offen offset:1024 nt
    s_waitcnt vmcnt(3)
    buffer_load_dwordx4 v[168:171], v2, s[40:43], s63 offen offset:2048 nt
    s_waitcnt vmcnt(3)
    buffer_load_dwordx4 v[172:175], v2, s[40:43], s63 offen offset:3072 nt
    s_add_u32 s63, s62, 4096
    s_waitcnt vmcnt(3)
    buffer_load_dwordx4 v[176:179], v2, s[40:43], s63 offen offset:0 nt
    s_waitcnt vmcnt(3)
    buffer_load_dwordx4 v[180:183], v2, s[40:43], s63 offen offset:1024 nt
    s_waitcnt vmcnt(3)
    buffer_load_dwordx4 v[184:187], v2, s[40:43], s63 offen offset:2048 nt
    s_waitcnt vmcnt(3)
    buffer_load_dwordx4 v[188:191], v2, s[40:43], s63 offen offset:3072 nt
    s_lshl_b32 s60, s34, 2
    s_and_b32 s61, s35, 3
    s_add_u32 s60, s60, s61
    s_lshl_b32 s60, s60, 7
    s_add_u32 s60, s60, 1114112
    s_mov_b32 s83, 0
L_qb_8:
    s_load_dwordx16 s[64:79], s[30:31], s60 glc
    s_waitcnt lgkmcnt(0)
    s_xor_b64 s[64:65], s[64:65], s[84:85]
    s_xor_b64 s[66:67], s[66:67], s[84:85]
    s_xor_b64 s[68:69], s[68:69], s[84:85]
    s_xor_b64 s[70:71], s[70:71], s[84:85]
    s_xor_b64 s[72:73], s[72:73], s[84:85]
    s_xor_b64 s[74:75], s[74:75], s[84:85]
    s_xor_b64 s[76:77], s[76:77], s[84:85]
    s_xor_b64 s[78:79], s[78:79], s[84:85]
    s_or_b64 s[64:65], s[64:65], s[66:67]
    s_or_b64 s[64:65], s[64:65], s[68:69]
    s_or_b64 s[64:65], s[64:65], s[70:71]
    s_or_b64 s[64:65], s[64:65], s[72:73]
    s_or_b64 s[64:65], s[64:65], s[74:75]
    s_or_b64 s[64:65], s[64:65], s[76:77]
    s_or_b64 s[64:65], s[64:65], s[78:79]
    s_cbranch_scc0 L_qb_ok_9
    s_add_u32 s83, s83, 1
    s_cmp_lt_u32 s83, 1048576
    s_cbranch_scc1 L_qb_8
L_qb_ok_9:
    v_and_b32 v8, 3, v0
    v_lshlrev_b32 v8, 11, v8
    v_bfe_u32 v9, v0, 2, 2
    v_lshl_add_u32 v8, v9, 5, v8
    v_lshrrev_b32 v9, 4, v0
    v_lshl_add_u32 v8, v9, 7, v8
    s_lshl_b32 s60, s34, 13
    buffer_load_dwordx4 v[96:99], v8, s[48:51], s60 offen offset:0 sc1
    buffer_load_dwordx4 v[100:103], v8, s[48:51], s60 offen offset:16 sc1
    buffer_load_dwordx4 v[104:107], v8, s[48:51], s60 offen offset:512 sc1
    buffer_load_dwordx4 v[108:111], v8, s[48:51], s60 offen offset:528 sc1
    buffer_load_dwordx4 v[112:115], v8, s[48:51], s60 offen offset:1024 sc1
    buffer_load_dwordx4 v[116:119], v8, s[48:51], s60 offen offset:1040 sc1
    buffer_load_dwordx4 v[120:123], v8, s[48:51], s60 offen offset:1536 sc1
    buffer_load_dwordx4 v[124:127], v8, s[48:51], s60 offen offset:1552 sc1
    s_waitcnt vmcnt(0)
    v_add_f32 v96, v96, v104
    v_add_f32 v112, v112, v120
    v_add_f32 v97, v97, v105
    v_add_f32 v113, v113, v121
    v_add_f32 v98, v98, v106
    v_add_f32 v114, v114, v122
    v_add_f32 v99, v99, v107
    v_add_f32 v115, v115, v123
    v_add_f32 v100, v100, v108
    v_add_f32 v116, v116, v124
    v_add_f32 v101, v101, v109
    v_add_f32 v117, v117, v125
    v_add_f32 v102, v102, v110
    v_add_f32 v118, v118, v126
    v_add_f32 v103, v103, v111
    v_add_f32 v119, v119, v127
    v_add_f32 v96, v96, v112
    v_add_f32 v97, v97, v113
    v_add_f32 v98, v98, v114
    v_add_f32 v99, v99, v115
    v_add_f32 v100, v100, v116
    v_add_f32 v101, v101, v117
    v_add_f32 v102, v102, v118
    v_add_f32 v103, v103, v119
    v_cvt_pk_bf16_f32 v28, v96, v97
    v_cvt_pk_bf16_f32 v29, v98, v99
    v_cvt_pk_bf16_f32 v30, v100, v101
    v_cvt_pk_bf16_f32 v31, v102, v103
    ds_write_b128 v2, v[28:31]
    ds_write_b32 v18, v18 offset:1280
    ds_write_b32 v18, v18 offset:1284
    s_waitcnt lgkmcnt(0)
    s_barrier
    v_mfma_f32_16x16x32_bf16 v[32:35], v[64:67], v[28:31], 0
    v_mfma_f32_16x16x32_bf16 v[36:39], v[68:71], v[28:31], 0
    v_mfma_f32_16x16x32_bf16 v[40:43], v[72:75], v[28:31], 0
    v_mfma_f32_16x16x32_bf16 v[44:47], v[76:79], v[28:31], 0
    v_mfma_f32_16x16x32_bf16 v[48:51], v[80:83], v[28:31], 0
    v_mfma_f32_16x16x32_bf16 v[52:55], v[84:87], v[28:31], 0
    v_mfma_f32_16x16x32_bf16 v[56:59], v[88:91], v[28:31], 0
    v_mfma_f32_16x16x32_bf16 v[60:63], v[92:95], v[28:31], 0
    s_nop 0
    v_add_f32_dpp v64, v33, v32 row_shl:4 row_mask:0xf bank_mask:0xf
    v_add_f32_dpp v65, v37, v36 row_shl:4 row_mask:0xf bank_mask:0xf
    v_add_f32_dpp v66, v41, v40 row_shl:4 row_mask:0xf bank_mask:0xf
    v_add_f32_dpp v67, v45, v44 row_shl:4 row_mask:0xf bank_mask:0xf
    v_add_f32_dpp v68, v49, v48 row_shl:4 row_mask:0xf bank_mask:0xf
    v_add_f32_dpp v69, v53, v52 row_shl:4 row_mask:0xf bank_mask:0xf
    v_add_f32_dpp v70, v57, v56 row_shl:4 row_mask:0xf bank_mask:0xf
    v_add_f32_dpp v71, v61, v60 row_shl:4 row_mask:0xf bank_mask:0xf
    v_add_f32_dpp v34, v35, v34 row_shl:4 row_mask:0xf bank_mask:0xf
    v_add_f32_dpp v38, v39, v38 row_shl:4 row_mask:0xf bank_mask:0xf
    v_add_f32_dpp v42, v43, v42 row_shl:4 row_mask:0xf bank_mask:0xf
    v_add_f32_dpp v46, v47, v46 row_shl:4 row_mask:0xf bank_mask:0xf
    v_add_f32_dpp v50, v51, v50 row_shl:4 row_mask:0xf bank_mask:0xf
    v_add_f32_dpp v54, v55, v54 row_shl:4 row_mask:0xf bank_mask:0xf
    v_add_f32_dpp v58, v59, v58 row_shl:4 row_mask:0xf bank_mask:0xf
    v_add_f32_dpp v62, v63, v62 row_shl:4 row_mask:0xf bank_mask:0xf
    v_add_f32_dpp v64, v34, v64 row_shl:8 row_mask:0xf bank_mask:0xf
    v_add_f32_dpp v65, v38, v65 row_shl:8 row_mask:0xf bank_mask:0xf
    v_add_f32_dpp v66, v42, v66 row_shl:8 row_mask:0xf bank_mask:0xf
    v_add_f32_dpp v67, v46, v67 row_shl:8 row_mask:0xf bank_mask:0xf
    v_add_f32_dpp v68, v50, v68 row_shl:8 row_mask:0xf bank_mask:0xf
    v_add_f32_dpp v69, v54, v69 row_shl:8 row_mask:0xf bank_mask:0xf
    v_add_f32_dpp v70, v58, v70 row_shl:8 row_mask:0xf bank_mask:0xf
    v_add_f32_dpp v71, v62, v71 row_shl:8 row_mask:0xf bank_mask:0xf
    v_max3_f32 v4, v64, v65, v66
    v_max3_f32 v4, v4, v67, v68
    v_max3_f32 v4, v4, v69, v70
    v_max_f32 v4, v4, v71
    v_mov_b32 v5, v4
    s_nop 1
    v_permlane16_swap_b32 v4, v5
    v_max_f32 v4, v4, v5
    v_mov_b32 v5, v4
    s_nop 1
    v_permlane32_swap_b32 v4, v5
    v_max_f32 v4, v4, v5
    v_mul_f32 v4, s82, v4
    s_mov_b64 exec, 0xf
    ds_write_b32 v6, v4 offset:1024
    s_mov_b64 exec, -1
    s_waitcnt lgkmcnt(0)
    s_barrier
    ds_read_b128 v[8:11], v7 offset:1024
    ds_read_b128 v[12:15], v7 offset:1040
    s_waitcnt lgkmcnt(0)
    v_max3_f32 v8, v8, v9, v10
    v_max3_f32 v12, v11, v12, v13
    v_max3_f32 v8, v8, v14, v15
    v_max_f32 v16, v8, v12
    v_fma_f32 v64, v64, s82, -v16
    v_fma_f32 v65, v65, s82, -v16
    v_fma_f32 v66, v66, s82, -v16
    v_fma_f32 v67, v67, s82, -v16
    v_fma_f32 v68, v68, s82, -v16
    v_fma_f32 v69, v69, s82, -v16
    v_fma_f32 v70, v70, s82, -v16
    v_fma_f32 v71, v71, s82, -v16
    v_exp_f32 v64, v64
    v_exp_f32 v65, v65
    v_exp_f32 v66, v66
    v_exp_f32 v67, v67
    v_exp_f32 v68, v68
    v_exp_f32 v69, v69
    v_exp_f32 v70, v70
    v_exp_f32 v71, v71
    v_add_f32 v4, v64, v65
    v_add_f32 v5, v66, v67
    v_add_f32 v4, v4, v68
    v_add_f32 v5, v5, v69
    v_add_f32 v4, v4, v70
    v_add_f32 v5, v5, v71
    v_add_f32 v4, v4, v5
    v_cvt_pk_bf16_f32 v64, v64, v65
    v_cvt_pk_bf16_f32 v65, v66, v67
    v_cvt_pk_bf16_f32 v66, v68, v69
    v_cvt_pk_bf16_f32 v67, v70, v71
    v_mov_b32 v5, v4
    s_nop 1
    v_permlane16_swap_b32 v4, v5
    v_add_f32 v4, v4, v5
    v_mov_b32 v5, v4
    s_nop 1
    v_permlane32_swap_b32 v4, v5
    v_add_f32 v4, v4, v5
    s_mov_b64 exec, 0xf
    ds_write_b32 v6, v4 offset:1152
    s_mov_b64 exec, -1
    s_waitcnt lgkmcnt(0)
    s_barrier
    ds_read_b128 v[8:11], v7 offset:1152
    ds_read_b128 v[12:15], v7 offset:1168
    v_lshlrev_b32 v4, 8, v0
    s_lshl_b32 s60, s34, 10
    s_lshl_b32 s61, s35, 3
    s_add_u32 s60, s60, s61
    s_add_u32 s60, s60, 131072
    s_waitcnt lgkmcnt(0)
    v_add_f32 v8, v8, v9
    v_add_f32 v10, v10, v11
    v_add_f32 v12, v12, v13
    v_add_f32 v14, v14, v15
    v_add_f32 v8, v8, v10
    v_add_f32 v12, v12, v14
    v_mov_b32 v20, v16
    v_add_f32 v21, v8, v12
    s_mov_b64 exec, 0xf
    buffer_store_dwordx2 v[20:21], v4, s[48:51], s60 offen sc1
    s_mov_b64 exec, -1
    v_perm_b32 v128, v164, v160, s80
    v_perm_b32 v132, v164, v160, s81
    v_perm_b32 v136, v165, v161, s80
    v_perm_b32 v140, v165, v161, s81
    v_perm_b32 v144, v166, v162, s80
    v_perm_b32 v148, v166, v162, s81
    v_perm_b32 v152, v167, v163, s80
    v_perm_b32 v156, v167, v163, s81
    v_perm_b32 v129, v172, v168, s80
    v_perm_b32 v133, v172, v168, s81
    v_perm_b32 v137, v173, v169, s80
    v_perm_b32 v141, v173, v169, s81
    v_perm_b32 v145, v174, v170, s80
    v_perm_b32 v149, v174, v170, s81
    v_perm_b32 v153, v175, v171, s80
    v_perm_b32 v157, v175, v171, s81
    v_perm_b32 v130, v180, v176, s80
    v_perm_b32 v134, v180, v176, s81
    v_perm_b32 v138, v181, v177, s80
    v_perm_b32 v142, v181, v177, s81
    v_perm_b32 v146, v182, v178, s80
    v_perm_b32 v150, v182, v178, s81
    v_perm_b32 v154, v183, v179, s80
    v_perm_b32 v158, v183, v179, s81
    v_perm_b32 v131, v188, v184, s80
    v_perm_b32 v135, v188, v184, s81
    v_perm_b32 v139, v189, v185, s80
    v_perm_b32 v143, v189, v185, s81
    v_perm_b32 v147, v190, v186, s80
    v_perm_b32 v151, v190, v186, s81
    v_perm_b32 v155, v191, v187, s80
    v_perm_b32 v159, v191, v187, s81
    v_mfma_f32_16x16x32_bf16 v[32:35], v[128:131], v[64:67], 0
    v_mfma_f32_16x16x32_bf16 v[36:39], v[132:135], v[64:67], 0
    v_mfma_f32_16x16x32_bf16 v[40:43], v[136:139], v[64:67], 0
    v_mfma_f32_16x16x32_bf16 v[44:47], v[140:143], v[64:67], 0
    v_mfma_f32_16x16x32_bf16 v[48:51], v[144:147], v[64:67], 0
    v_mfma_f32_16x16x32_bf16 v[52:55], v[148:151], v[64:67], 0
    v_mfma_f32_16x16x32_bf16 v[56:59], v[152:155], v[64:67], 0
    v_mfma_f32_16x16x32_bf16 v[60:63], v[156:159], v[64:67], 0
    s_mov_b32 exec_lo, 0x000f000f
    s_mov_b32 exec_hi, 0x000f000f
    ds_write_b128 v17, v[32:35] offset:2048
    ds_write_b128 v17, v[36:39] offset:2112
    ds_write_b128 v17, v[40:43] offset:2176
    ds_write_b128 v17, v[44:47] offset:2240
    ds_write_b128 v17, v[48:51] offset:2304
    ds_write_b128 v17, v[52:55] offset:2368
    ds_write_b128 v17, v[56:59] offset:2432
    ds_write_b128 v17, v[60:63] offset:2496
    s_mov_b64 exec, 1
    ds_add_u32 v18, v19 offset:1280
    s_mov_b64 exec, -1
    s_branch L_B7T
L_B7N:
    v_mov_b32 v10, 4286578688
    s_mov_b64 exec, 0xf
    ds_write_b32 v6, v10 offset:1024
    ds_write_b32 v6, v18 offset:1152
    s_mov_b64 exec, -1
    v_mov_b32 v32, 0
    v_mov_b32 v33, 0
    v_mov_b32 v34, 0
    v_mov_b32 v35, 0
    v_mov_b32 v36, 0
    v_mov_b32 v37, 0
    v_mov_b32 v38, 0
    v_mov_b32 v39, 0
    v_mov_b32 v40, 0
    v_mov_b32 v41, 0
    v_mov_b32 v42, 0
    v_mov_b32 v43, 0
    v_mov_b32 v44, 0
    v_mov_b32 v45, 0
    v_mov_b32 v46, 0
    v_mov_b32 v47, 0
    v_mov_b32 v48, 0
    v_mov_b32 v49, 0
    v_mov_b32 v50, 0
    v_mov_b32 v51, 0
    v_mov_b32 v52, 0
    v_mov_b32 v53, 0
    v_mov_b32 v54, 0
    v_mov_b32 v55, 0
    v_mov_b32 v56, 0
    v_mov_b32 v57, 0
    v_mov_b32 v58, 0
    v_mov_b32 v59, 0
    v_mov_b32 v60, 0
    v_mov_b32 v61, 0
    v_mov_b32 v62, 0
    v_mov_b32 v63, 0
    s_mov_b32 exec_lo, 0x000f000f
    s_mov_b32 exec_hi, 0x000f000f
    ds_write_b128 v17, v[32:35] offset:2048
    ds_write_b128 v17, v[36:39] offset:2112
    ds_write_b128 v17, v[40:43] offset:2176
    ds_write_b128 v17, v[44:47] offset:2240
    ds_write_b128 v17, v[48:51] offset:2304
    ds_write_b128 v17, v[52:55] offset:2368
    ds_write_b128 v17, v[56:59] offset:2432
    ds_write_b128 v17, v[60:63] offset:2496
    s_mov_b64 exec, -1
    s_lshl_b32 s60, s34, 2
    s_and_b32 s61, s35, 3
    s_add_u32 s60, s60, s61
    s_lshl_b32 s60, s60, 7
    s_add_u32 s60, s60, 1114112
    s_mov_b32 s83, 0
L_qb_10:
    s_load_dwordx16 s[64:79], s[30:31], s60 glc
    s_waitcnt lgkmcnt(0)
    s_xor_b64 s[64:65], s[64:65], s[84:85]
    s_xor_b64 s[66:67], s[66:67], s[84:85]
    s_xor_b64 s[68:69], s[68:69], s[84:85]
    s_xor_b64 s[70:71], s[70:71], s[84:85]
    s_xor_b64 s[72:73], s[72:73], s[84:85]
    s_xor_b64 s[74:75], s[74:75], s[84:85]
    s_xor_b64 s[76:77], s[76:77], s[84:85]
    s_xor_b64 s[78:79], s[78:79], s[84:85]
    s_or_b64 s[64:65], s[64:65], s[66:67]
    s_or_b64 s[64:65], s[64:65], s[68:69]
    s_or_b64 s[64:65], s[64:65], s[70:71]
    s_or_b64 s[64:65], s[64:65], s[72:73]
    s_or_b64 s[64:65], s[64:65], s[74:75]
    s_or_b64 s[64:65], s[64:65], s[76:77]
    s_or_b64 s[64:65], s[64:65], s[78:79]
    s_cbranch_scc0 L_qb_ok_11
    s_add_u32 s83, s83, 1
    s_cmp_lt_u32 s83, 1048576
    s_cbranch_scc1 L_qb_10
L_qb_ok_11:
    v_and_b32 v8, 3, v0
    v_lshlrev_b32 v8, 11, v8
    v_bfe_u32 v9, v0, 2, 2
    v_lshl_add_u32 v8, v9, 5, v8
    v_lshrrev_b32 v9, 4, v0
    v_lshl_add_u32 v8, v9, 7, v8
    s_lshl_b32 s60, s34, 13
    buffer_load_dwordx4 v[96:99], v8, s[48:51], s60 offen offset:0 sc1
    buffer_load_dwordx4 v[100:103], v8, s[48:51], s60 offen offset:16 sc1
    buffer_load_dwordx4 v[104:107], v8, s[48:51], s60 offen offset:512 sc1
    buffer_load_dwordx4 v[108:111], v8, s[48:51], s60 offen offset:528 sc1
    buffer_load_dwordx4 v[112:115], v8, s[48:51], s60 offen offset:1024 sc1
    buffer_load_dwordx4 v[116:119], v8, s[48:51], s60 offen offset:1040 sc1
    buffer_load_dwordx4 v[120:123], v8, s[48:51], s60 offen offset:1536 sc1
    buffer_load_dwordx4 v[124:127], v8, s[48:51], s60 offen offset:1552 sc1
    s_waitcnt vmcnt(0)
    v_add_f32 v96, v96, v104
    v_add_f32 v112, v112, v120
    v_add_f32 v97, v97, v105
    v_add_f32 v113, v113, v121
    v_add_f32 v98, v98, v106
    v_add_f32 v114, v114, v122
    v_add_f32 v99, v99, v107
    v_add_f32 v115, v115, v123
    v_add_f32 v100, v100, v108
    v_add_f32 v116, v116, v124
    v_add_f32 v101, v101, v109
    v_add_f32 v117, v117, v125
    v_add_f32 v102, v102, v110
    v_add_f32 v118, v118, v126
    v_add_f32 v103, v103, v111
    v_add_f32 v119, v119, v127
    v_add_f32 v96, v96, v112
    v_add_f32 v97, v97, v113
    v_add_f32 v98, v98, v114
    v_add_f32 v99, v99, v115
    v_add_f32 v100, v100, v116
    v_add_f32 v101, v101, v117
    v_add_f32 v102, v102, v118
    v_add_f32 v103, v103, v119
    v_cvt_pk_bf16_f32 v28, v96, v97
    v_cvt_pk_bf16_f32 v29, v98, v99
    v_cvt_pk_bf16_f32 v30, v100, v101
    v_cvt_pk_bf16_f32 v31, v102, v103
    ds_write_b128 v2, v[28:31]
    ds_write_b32 v18, v18 offset:1280
    ds_write_b32 v18, v18 offset:1284
    s_waitcnt lgkmcnt(0)
    s_barrier
    s_barrier
    ds_read_b128 v[8:11], v7 offset:1024
    ds_read_b128 v[12:15], v7 offset:1040
    s_waitcnt lgkmcnt(0)
    v_max3_f32 v8, v8, v9, v10
    v_max3_f32 v12, v11, v12, v13
    v_max3_f32 v8, v8, v14, v15
    v_max_f32 v16, v8, v12
    s_barrier
    ds_read_b128 v[8:11], v7 offset:1152
    ds_read_b128 v[12:15], v7 offset:1168
    v_lshlrev_b32 v4, 8, v0
    s_lshl_b32 s60, s34, 10
    s_lshl_b32 s61, s35, 3
    s_add_u32 s60, s60, s61
    s_add_u32 s60, s60, 131072
    s_waitcnt lgkmcnt(0)
    v_add_f32 v8, v8, v9
    v_add_f32 v10, v10, v11
    v_add_f32 v12, v12, v13
    v_add_f32 v14, v14, v15
    v_add_f32 v8, v8, v10
    v_add_f32 v12, v12, v14
    v_mov_b32 v20, v16
    v_add_f32 v21, v8, v12
    s_mov_b64 exec, 0xf
    buffer_store_dwordx2 v[20:21], v4, s[48:51], s60 offen sc1
    s_mov_b64 exec, -1
    s_mov_b64 exec, 1
    ds_add_u32 v18, v19 offset:1280
    s_mov_b64 exec, -1
L_B7T:
    s_lshl_b32 s60, s34, 8
    s_lshl_b32 s61, s35, 2
    s_add_u32 s60, s60, s61
    s_add_u32 s60, s60, 1212416
    s_waitcnt vmcnt(0) lgkmcnt(0)
    v_mov_b32 v20, s84
    v_lshlrev_b32 v21, 7, v0
    s_mov_b64 exec, 0x3
    buffer_store_dword v20, v21, s[48:51], s60 offen sc1
    s_mov_b64 exec, -1
    v_lshrrev_b32 v9, 3, v0
    v_and_b32 v8, 7, v0
    v_lshlrev_b32 v4, 9, v9
    v_lshl_add_u32 v4, v8, 4, v4
    v_lshlrev_b32 v8, 3, v8
    v_lshrrev_b32 v11, 4, v0
    v_lshl_add_u32 v8, v11, 1, v8
    s_mul_i32 s56, s86, 12288
    s_lshl_b32 s57, s87, 7
    s_add_u32 s56, s56, s57
    s_add_u32 s56, s56, 1245184
    s_add_u32 s57, s56, 4096
    s_add_u32 s58, s56, 8192
    s_cmp_eq_u32 s33, 3
    s_cselect_b32 s56, 8388608, s56
    s_cselect_b32 s57, 8388608, s57
    s_cselect_b32 s58, 8388608, s58
    buffer_load_dwordx4 v[64:67], v4, s[48:51], s56 offen sc1
    buffer_load_dwordx4 v[68:71], v4, s[48:51], s57 offen sc1
    buffer_load_dwordx4 v[72:75], v4, s[48:51], s58 offen sc1
    s_cmp_eq_u32 s33, 3
    s_cbranch_scc1 L_B7F
    s_lshl_b32 s60, s34, 1
    s_and_b32 s61, s35, 1
    s_add_u32 s60, s60, s61
    s_lshl_b32 s60, s60, 7
    s_add_u32 s60, s60, 1212416
    v_lshlrev_b32 v10, 3, v9
    s_lshl_b32 s62, s86, 8
    s_add_u32 s62, s62, 131072
    s_mov_b32 s83, 0
    s_add_u32 s61, s60, 64
L_fs_12:
    s_load_dwordx16 s[64:79], s[30:31], s60 glc
    s_load_dwordx8 s[4:11], s[30:31], s61 glc
    s_waitcnt lgkmcnt(0)
    s_xor_b64 s[64:65], s[64:65], s[84:85]
    s_xor_b64 s[66:67], s[66:67], s[84:85]
    s_xor_b64 s[68:69], s[68:69], s[84:85]
    s_xor_b64 s[70:71], s[70:71], s[84:85]
    s_xor_b64 s[72:73], s[72:73], s[84:85]
    s_xor_b64 s[74:75], s[74:75], s[84:85]
    s_xor_b64 s[76:77], s[76:77], s[84:85]
    s_xor_b64 s[78:79], s[78:79], s[84:85]
    s_xor_b64 s[4:5], s[4:5], s[84:85]
    s_xor_b64 s[6:7], s[6:7], s[84:85]
    s_xor_b64 s[8:9], s[8:9], s[84:85]
    s_xor_b64 s[10:11], s[10:11], s[84:85]
    s_or_b64 s[64:65], s[64:65], s[66:67]
    s_or_b64 s[64:65], s[64:65], s[68:69]
    s_or_b64 s[64:65], s[64:65], s[70:71]
    s_or_b64 s[64:65], s[64:65], s[72:73]
    s_or_b64 s[64:65], s[64:65], s[74:75]
    s_or_b64 s[64:65], s[64:65], s[76:77]
    s_or_b64 s[64:65], s[64:65], s[78:79]
    s_or_b64 s[64:65], s[64:65], s[4:5]
    s_or_b64 s[64:65], s[64:65], s[6:7]
    s_or_b64 s[64:65], s[64:65], s[8:9]
    s_or_b64 s[64:65], s[64:65], s[10:11]
    s_cbranch_scc0 L_fs_ok_13
    s_add_u32 s83, s83, 1
    s_cmp_lt_u32 s83, 1048576
    s_cbranch_scc1 L_fs_12
L_fs_ok_13:
    s_lshl_b32 s60, s34, 2
    s_add_u32 s60, s60, 1163264
    s_cmp_eq_u32 s35, 0
    s_cselect_b32 s60, s60, 8388608
    buffer_load_dwordx2 v[22:23], v10, s[48:51], s62 offen offset:0 sc1
    buffer_load_dwordx2 v[24:25], v10, s[48:51], s62 offen offset:64 sc1
    buffer_load_dwordx2 v[26:27], v10, s[48:51], s62 offen offset:128 sc1
    s_waitcnt vmcnt(0)
    v_max3_f32 v12, v22, v24, v26
    s_nop 1
    v_max_f32_dpp v12, v12, v12 row_ror:8 row_mask:0xf bank_mask:0xf
    v_mov_b32 v13, v12
    s_nop 1
    v_permlane16_swap_b32 v12, v13
    v_max_f32 v12, v12, v13
    v_mov_b32 v13, v12
    s_nop 1
    v_permlane32_swap_b32 v12, v13
    v_max_f32 v12, v12, v13
    v_sub_f32 v22, v22, v12
    v_sub_f32 v24, v24, v12
    v_sub_f32 v26, v26, v12
    v_exp_f32 v22, v22
    v_exp_f32 v24, v24
    v_exp_f32 v26, v26
    v_mul_f32 v12, v22, v23
    v_fmac_f32 v12, v24, v25
    v_fmac_f32 v12, v26, v27
    s_nop 1
    v_add_f32_dpp v12, v12, v12 row_ror:8 row_mask:0xf bank_mask:0xf
    v_mov_b32 v13, v12
    s_nop 1
    v_permlane16_swap_b32 v12, v13
    v_add_f32 v12, v12, v13
    v_mov_b32 v13, v12
    s_nop 1
    v_permlane32_swap_b32 v12, v13
    v_add_f32 v12, v12, v13
    v_rcp_f32 v12, v12
    s_nop 0
    v_mul_f32 v22, v22, v12
    v_mul_f32 v24, v24, v12
    v_mul_f32 v26, v26, v12
    s_nop 1
L_B7_iss:
    s_sleep 1
    ds_read_b32 v13, v18 offset:1284
    s_waitcnt lgkmcnt(0)
    v_cmp_ne_u32 vcc, 7, v13
    s_nop 3
    s_cbranch_vccnz L_B7_iss
    s_bfe_u32 s72, s84, 0xc0000
    s_bfe_u32 s73, s84, 0xc0007
    s_bfe_u32 s74, s84, 0xc000e
    s_bfe_u32 s75, s84, 0xc0014
    s_movk_i32 s76, 0xfff
    buffer_load_dwordx4 v[64:67], v4, s[48:51], s56 offen sc1
    buffer_load_dwordx4 v[68:71], v4, s[48:51], s57 offen sc1
    buffer_load_dwordx4 v[72:75], v4, s[48:51], s58 offen sc1
    s_mov_b32 s83, 0
L_co_14:
    s_sleep 2
    buffer_load_dwordx4 v[96:99], v4, s[48:51], s56 offen sc1
    buffer_load_dwordx4 v[100:103], v4, s[48:51], s57 offen sc1
    buffer_load_dwordx4 v[104:107], v4, s[48:51], s58 offen sc1
    s_waitcnt vmcnt(3)
    v_xor_b32 v64, s72, v64
    v_xor_b32 v65, s73, v65
    v_xor_b32 v66, s74, v66
    v_xor_b32 v67, s75, v67
    v_xor_b32 v68, s72, v68
    v_xor_b32 v69, s73, v69
    v_xor_b32 v70, s74, v70
    v_xor_b32 v71, s75, v71
    v_xor_b32 v72, s72, v72
    v_xor_b32 v73, s73, v73
    v_xor_b32 v74, s74, v74
    v_xor_b32 v75, s75, v75
    v_or_b32 v10, v64, v65
    v_or_b32 v11, v66, v67
    v_or3_b32 v10, v10, v68, v69
    v_or3_b32 v11, v11, v70, v71
    v_or3_b32 v10, v10, v72, v73
    v_or3_b32 v11, v11, v74, v75
    v_or_b32 v10, v10, v11
    v_and_b32 v10, s76, v10
    v_cmp_ne_u32 vcc, 0, v10
    s_nop 3
    s_cbranch_vccz L_co_ok_15
    s_sleep 2
    s_and_b32 s61, s83, 15
    s_cmp_eq_u32 s61, 15
    s_cselect_b32 s61, 1048576, 0
    s_sub_u32 s64, s56, s61
    s_sub_u32 s65, s57, s61
    s_sub_u32 s66, s58, s61
    buffer_load_dwordx4 v[64:67], v4, s[48:51], s64 offen sc1
    buffer_load_dwordx4 v[68:71], v4, s[48:51], s65 offen sc1
    buffer_load_dwordx4 v[72:75], v4, s[48:51], s66 offen sc1
    s_waitcnt vmcnt(3)
    v_xor_b32 v96, s72, v96
    v_xor_b32 v97, s73, v97
    v_xor_b32 v98, s74, v98
    v_xor_b32 v99, s75, v99
    v_xor_b32 v100, s72, v100
    v_xor_b32 v101, s73, v101
    v_xor_b32 v102, s74, v102
    v_xor_b32 v103, s75, v103
    v_xor_b32 v104, s72, v104
    v_xor_b32 v105, s73, v105
    v_xor_b32 v106, s74, v106
    v_xor_b32 v107, s75, v107
    v_or_b32 v10, v96, v97
    v_or_b32 v11, v98, v99
    v_or3_b32 v10, v10, v100, v101
    v_or3_b32 v11, v11, v102, v103
    v_or3_b32 v10, v10, v104, v105
    v_or3_b32 v11, v11, v106, v107
    v_or_b32 v10, v10, v11
    v_and_b32 v10, s76, v10
    v_cmp_ne_u32 vcc, 0, v10
    s_nop 3
    s_cbranch_vccz L_co_ok2_16
    s_add_u32 s83, s83, 1
    s_cmp_lt_u32 s83, 1048576
    s_cbranch_scc1 L_co_14
L_co_ok2_16:
    v_mul_f32 v128, v22, v96
    v_mul_f32 v129, v22, v97
    v_mul_f32 v130, v22, v98
    v_mul_f32 v131, v22, v99
    v_fmac_f32 v128, v24, v100
    v_fmac_f32 v129, v24, v101
    v_fmac_f32 v130, v24, v102
    v_fmac_f32 v131, v24, v103
    v_fmac_f32 v128, v26, v104
    v_fmac_f32 v129, v26, v105
    v_fmac_f32 v130, v26, v106
    v_fmac_f32 v131, v26, v107
    s_nop 0
    s_branch L_co_ok_15_b
L_co_ok_15:
    v_mul_f32 v128, v22, v64
    v_mul_f32 v129, v22, v65
    v_mul_f32 v130, v22, v66
    v_mul_f32 v131, v22, v67
    v_fmac_f32 v128, v24, v68
    v_fmac_f32 v129, v24, v69
    v_fmac_f32 v130, v24, v70
    v_fmac_f32 v131, v24, v71
    v_fmac_f32 v128, v26, v72
    v_fmac_f32 v129, v26, v73
    v_fmac_f32 v130, v26, v74
    v_fmac_f32 v131, v26, v75
    s_nop 1
L_co_ok_15_b:
    v_mov_b32 v20, s84
    v_lshlrev_b32 v21, 7, v0
    s_mov_b32 exec_hi, 0
    buffer_store_dword v20, v21, s[48:51], s60 offen sc1
    s_mov_b64 exec, -1
    v_permlane32_swap_b32 v128, v130
    v_permlane32_swap_b32 v129, v131
    v_add_f32 v128, v128, v130
    v_add_f32 v129, v129, v131
    s_nop 1
    v_permlane16_swap_b32 v128, v129
    v_add_f32 v128, v128, v129
    s_nop 1
    v_add_f32_dpp v128, v128, v128 row_ror:8 row_mask:0xf bank_mask:0xf
    v_cvt_pk_bf16_f32 v128, v128, v128
    ds_write_b16 v8, v128
    s_mov_b64 exec, -1
    s_waitcnt lgkmcnt(0)
    s_barrier
    s_branch L_fin
L_B7F:
    s_xor_b32 s3, s35, s34
    s_and_b32 s3, s3, 1
    s_cmp_eq_u32 s3, 0
    s_cbranch_scc0 L_fin
    s_lshl_b32 s3, s34, 2
    s_bfe_u32 s60, s35, 0x20001
    s_add_u32 s3, s3, s60
    s_lshl_b32 s60, s3, 7
    s_add_u32 s60, s60, 1163264
    v_lshrrev_b32 v4, 2, v0
    v_lshlrev_b32 v4, 11, v4
    v_and_b32 v5, 3, v0
    v_lshl_add_u32 v4, v5, 4, v4
    s_bfe_u32 s72, s84, 0xc0000
    s_bfe_u32 s73, s84, 0xc0007
    s_bfe_u32 s74, s84, 0xc000e
    s_bfe_u32 s75, s84, 0xc0014
    s_movk_i32 s76, 0xfff
    s_lshl_b32 s61, s3, 6
    s_add_u32 s12, s61, 589824
    s_add_u32 s13, s12, 32768
    s_add_u32 s14, s12, 65536
    s_add_u32 s15, s12, 98304
    s_add_u32 s16, s12, 131072
    s_add_u32 s17, s12, 163840
    s_add_u32 s18, s12, 196608
    s_add_u32 s19, s12, 229376
    s_lshl_b32 s61, s3, 5
    s_add_u32 s61, s61, 1024
    v_lshl_add_u32 v5, v5, 3, s61
    v_lshrrev_b32 v6, 4, v0
    v_lshl_add_u32 v5, v6, 1, v5
    s_mov_b32 s83, 0
    s_nop 0
L_fg_17:
    s_load_dwordx8 s[64:71], s[30:31], s60 glc
    s_waitcnt lgkmcnt(0)
    s_xor_b64 s[64:65], s[64:65], s[84:85]
    s_xor_b64 s[66:67], s[66:67], s[84:85]
    s_xor_b64 s[68:69], s[68:69], s[84:85]
    s_xor_b64 s[70:71], s[70:71], s[84:85]
    s_or_b64 s[64:65], s[64:65], s[66:67]
    s_or_b64 s[64:65], s[64:65], s[68:69]
    s_or_b64 s[64:65], s[64:65], s[70:71]
    s_cbranch_scc0 L_fg_ok_18
    s_add_u32 s83, s83, 1
    s_cmp_lt_u32 s83, 1048576
    s_cbranch_scc1 L_fg_17
L_fg_ok_18:
    buffer_load_dwordx4 v[64:67], v4, s[48:51], s12 offen sc1
    buffer_load_dwordx4 v[68:71], v4, s[48:51], s13 offen sc1
    buffer_load_dwordx4 v[72:75], v4, s[48:51], s14 offen sc1
    buffer_load_dwordx4 v[76:79], v4, s[48:51], s15 offen sc1
    buffer_load_dwordx4 v[80:83], v4, s[48:51], s16 offen sc1
    buffer_load_dwordx4 v[84:87], v4, s[48:51], s17 offen sc1
    buffer_load_dwordx4 v[88:91], v4, s[48:51], s18 offen sc1
    buffer_load_dwordx4 v[92:95], v4, s[48:51], s19 offen sc1
    s_mov_b32 s83, 0
L_fin_19:
    buffer_load_dwordx4 v[96:99], v4, s[48:51], s12 offen sc1
    buffer_load_dwordx4 v[100:103], v4, s[48:51], s13 offen sc1
    buffer_load_dwordx4 v[104:107], v4, s[48:51], s14 offen sc1
    buffer_load_dwordx4 v[108:111], v4, s[48:51], s15 offen sc1
    buffer_load_dwordx4 v[112:115], v4, s[48:51], s16 offen sc1
    buffer_load_dwordx4 v[116:119], v4, s[48:51], s17 offen sc1
    buffer_load_dwordx4 v[120:123], v4, s[48:51], s18 offen sc1
    buffer_load_dwordx4 v[124:127], v4, s[48:51], s19 offen sc1
    s_waitcnt vmcnt(8)
    v_xor_b32 v64, s72, v64
    v_xor_b32 v65, s73, v65
    v_xor_b32 v66, s74, v66
    v_xor_b32 v67, s75, v67
    v_xor_b32 v68, s72, v68
    v_xor_b32 v69, s73, v69
    v_xor_b32 v70, s74, v70
    v_xor_b32 v71, s75, v71
    v_xor_b32 v72, s72, v72
    v_xor_b32 v73, s73, v73
    v_xor_b32 v74, s74, v74
    v_xor_b32 v75, s75, v75
    v_xor_b32 v76, s72, v76
    v_xor_b32 v77, s73, v77
    v_xor_b32 v78, s74, v78
    v_xor_b32 v79, s75, v79
    v_xor_b32 v80, s72, v80
    v_xor_b32 v81, s73, v81
    v_xor_b32 v82, s74, v82
    v_xor_b32 v83, s75, v83
    v_xor_b32 v84, s72, v84
    v_xor_b32 v85, s73, v85
    v_xor_b32 v86, s74, v86
    v_xor_b32 v87, s75, v87
    v_xor_b32 v88, s72, v88
    v_xor_b32 v89, s73, v89
    v_xor_b32 v90, s74, v90
    v_xor_b32 v91, s75, v91
    v_xor_b32 v92, s72, v92
    v_xor_b32 v93, s73, v93
    v_xor_b32 v94, s74, v94
    v_xor_b32 v95, s75, v95
    v_or_b32 v6, v64, v65
    v_or_b32 v7, v66, v67
    v_or3_b32 v6, v6, v68, v69
    v_or3_b32 v7, v7, v70, v71
    v_or3_b32 v6, v6, v72, v73
    v_or3_b32 v7, v7, v74, v75
    v_or3_b32 v6, v6, v76, v77
    v_or3_b32 v7, v7, v78, v79
    v_or3_b32 v6, v6, v80, v81
    v_or3_b32 v7, v7, v82, v83
    v_or3_b32 v6, v6, v84, v85
    v_or3_b32 v7, v7, v86, v87
    v_or3_b32 v6, v6, v88, v89
    v_or3_b32 v7, v7, v90, v91
    v_or3_b32 v6, v6, v92, v93
    v_or3_b32 v7, v7, v94, v95
    v_or_b32 v6, v6, v7
    v_and_b32 v6, s76, v6
    v_cmp_ne_u32 vcc, 0, v6
    s_nop 3
    s_cbranch_vccz L_fin_ok_20
    buffer_load_dwordx4 v[64:67], v4, s[48:51], s12 offen sc1
    buffer_load_dwordx4 v[68:71], v4, s[48:51], s13 offen sc1
    buffer_load_dwordx4 v[72:75], v4, s[48:51], s14 offen sc1
    buffer_load_dwordx4 v[76:79], v4, s[48:51], s15 offen sc1
    buffer_load_dwordx4 v[80:83], v4, s[48:51], s16 offen sc1
    buffer_load_dwordx4 v[84:87], v4, s[48:51], s17 offen sc1
    buffer_load_dwordx4 v[88:91], v4, s[48:51], s18 offen sc1
    buffer_load_dwordx4 v[92:95], v4, s[48:51], s19 offen sc1
    s_waitcnt vmcnt(8)
    v_xor_b32 v96, s72, v96
    v_xor_b32 v97, s73, v97
    v_xor_b32 v98, s74, v98
    v_xor_b32 v99, s75, v99
    v_xor_b32 v100, s72, v100
    v_xor_b32 v101, s73, v101
    v_xor_b32 v102, s74, v102
    v_xor_b32 v103, s75, v103
    v_xor_b32 v104, s72, v104
    v_xor_b32 v105, s73, v105
    v_xor_b32 v106, s74, v106
    v_xor_b32 v107, s75, v107
    v_xor_b32 v108, s72, v108
    v_xor_b32 v109, s73, v109
    v_xor_b32 v110, s74, v110
    v_xor_b32 v111, s75, v111
    v_xor_b32 v112, s72, v112
    v_xor_b32 v113, s73, v113
    v_xor_b32 v114, s74, v114
    v_xor_b32 v115, s75, v115
    v_xor_b32 v116, s72, v116
    v_xor_b32 v117, s73, v117
    v_xor_b32 v118, s74, v118
    v_xor_b32 v119, s75, v119
    v_xor_b32 v120, s72, v120
    v_xor_b32 v121, s73, v121
    v_xor_b32 v122, s74, v122
    v_xor_b32 v123, s75, v123
    v_xor_b32 v124, s72, v124
    v_xor_b32 v125, s73, v125
    v_xor_b32 v126, s74, v126
    v_xor_b32 v127, s75, v127
    v_or_b32 v6, v96, v97
    v_or_b32 v7, v98, v99
    v_or3_b32 v6, v6, v100, v101
    v_or3_b32 v7, v7, v102, v103
    v_or3_b32 v6, v6, v104, v105
    v_or3_b32 v7, v7, v106, v107
    v_or3_b32 v6, v6, v108, v109
    v_or3_b32 v7, v7, v110, v111
    v_or3_b32 v6, v6, v112, v113
    v_or3_b32 v7, v7, v114, v115
    v_or3_b32 v6, v6, v116, v117
    v_or3_b32 v7, v7, v118, v119
    v_or3_b32 v6, v6, v120, v121
    v_or3_b32 v7, v7, v122, v123
    v_or3_b32 v6, v6, v124, v125
    v_or3_b32 v7, v7, v126, v127
    v_or_b32 v6, v6, v7
    v_and_b32 v6, s76, v6
    v_cmp_ne_u32 vcc, 0, v6
    s_nop 3
    s_cbranch_vccz L_fin_ok2_21
    s_add_u32 s83, s83, 1
    s_cmp_lt_u32 s83, 1048576
    s_cbranch_scc1 L_fin_19
L_fin_ok2_21:
    v_pk_add_f32 v[8:9], v[96:97], v[100:101]
    v_pk_add_f32 v[10:11], v[98:99], v[102:103]
    v_pk_add_f32 v[12:13], v[104:105], v[108:109]
    v_pk_add_f32 v[14:15], v[106:107], v[110:111]
    v_pk_add_f32 v[16:17], v[112:113], v[116:117]
    v_pk_add_f32 v[18:19], v[114:115], v[118:119]
    v_pk_add_f32 v[20:21], v[120:121], v[124:125]
    v_pk_add_f32 v[22:23], v[122:123], v[126:127]
    s_nop 0
    s_branch L_fin_ok_20_b
L_fin_ok_20:
    v_pk_add_f32 v[8:9], v[64:65], v[68:69]
    v_pk_add_f32 v[10:11], v[66:67], v[70:71]
    v_pk_add_f32 v[12:13], v[72:73], v[76:77]
    v_pk_add_f32 v[14:15], v[74:75], v[78:79]
    v_pk_add_f32 v[16:17], v[80:81], v[84:85]
    v_pk_add_f32 v[18:19], v[82:83], v[86:87]
    v_pk_add_f32 v[20:21], v[88:89], v[92:93]
    v_pk_add_f32 v[22:23], v[90:91], v[94:95]
    s_nop 1
L_fin_ok_20_b:
    v_pk_add_f32 v[8:9], v[8:9], v[12:13]
    v_pk_add_f32 v[10:11], v[10:11], v[14:15]
    v_pk_add_f32 v[16:17], v[16:17], v[20:21]
    v_pk_add_f32 v[18:19], v[18:19], v[22:23]
    v_pk_add_f32 v[8:9], v[8:9], v[16:17]
    v_pk_add_f32 v[10:11], v[10:11], v[18:19]
    s_nop 1
    v_permlane32_swap_b32 v8, v10
    v_permlane32_swap_b32 v9, v11
    v_add_f32 v8, v8, v10
    v_add_f32 v9, v9, v11
    s_nop 1
    v_permlane16_swap_b32 v8, v9
    v_add_f32 v8, v8, v9
    s_nop 1
    v_add_f32_dpp v8, v8, v8 row_ror:4 row_mask:0xf bank_mask:0xf
    s_nop 1
    v_add_f32_dpp v8, v8, v8 row_ror:8 row_mask:0xf bank_mask:0xf
    v_cvt_pk_bf16_f32 v8, v8, v8
    s_mov_b32 exec_lo, 0x000f000f
    s_mov_b32 exec_hi, 0x000f000f
    global_store_short v5, v8, s[26:27]
    s_mov_b32 s60, 155776
    s_cmp_eq_u32 s3, 0
    s_cselect_b32 s60, s60, 8388608
    s_mov_b64 exec, 1
    v_mov_b32 v14, s84
    buffer_store_dword v14, off, s[48:51], s60
    s_mov_b64 exec, -1
    s_branch L_fin
L_A:
    s_lshr_b32 s60, s2, 5
    s_and_b32 s61, s2, 7
    s_lshl_b32 s34, s60, 3
    s_add_u32 s34, s34, s61
    s_lshl_b32 s35, s61, 3
    s_add_u32 s35, s35, s60
    s_lshl_b32 s62, s32, 19
    s_lshl_b32 s60, s35, 7
    s_add_u32 s62, s62, s60
    v_lshrrev_b32 v3, 4, v0
    v_and_b32 v18, 15, v0
    v_bfe_u32 v1, v0, 3, 1
    v_lshlrev_b32 v1, 18, v1
    v_lshl_add_u32 v1, v3, 16, v1
    v_and_b32 v4, 7, v0
    v_lshl_add_u32 v1, v4, 4, v1
    v_lshlrev_b32 v2, 4, v0
    s_and_b32 s60, s32, 1
    s_lshl_b32 s60, s60, 5
    v_xor_b32 v22, s60, v2
    s_xor_b32 s60, s60, 48
    v_xor_b32 v23, s60, v2
    s_lshl_b32 s86, s34, 18
    s_lshl_b32 s87, s32, 13
    s_add_u32 s86, s86, s87
    s_waitcnt lgkmcnt(0)
    s_load_dword s84, s[30:31], 155648
    s_mov_b32 s44, s6
    s_mov_b32 s45, s7
    s_mov_b32 s46, 16777216
    s_mov_b32 s47, 0x20000
    s_mov_b32 s48, s30
    s_mov_b32 s49, s31
    s_mov_b32 s50, 8388608
    s_mov_b32 s51, 0x20000
    s_add_u32 s59, s86, 0
    s_add_u32 m0, s87, 0
    v_xor_b32 v24, 0, v22
    s_waitcnt vmcnt(0)
    buffer_load_dwordx4 v24, s[44:47], s59 offen offset:0 nt lds
    v_xor_b32 v24, 64, v22
    s_waitcnt vmcnt(0)
    buffer_load_dwordx4 v24, s[44:47], s59 offen offset:1024 nt lds
    v_xor_b32 v24, 128, v22
    buffer_load_dwordx4 v24, s[44:47], s59 offen offset:2048 nt lds
    v_xor_b32 v24, 192, v22
    buffer_load_dwordx4 v24, s[44:47], s59 offen offset:3072 nt lds
    s_add_u32 s59, s86, 4096
    s_add_u32 m0, s87, 4096
    v_xor_b32 v24, 0, v23
    buffer_load_dwordx4 v24, s[44:47], s59 offen offset:0 nt lds
    v_xor_b32 v24, 64, v23
    s_waitcnt vmcnt(3)
    buffer_load_dwordx4 v24, s[44:47], s59 offen offset:1024 nt lds
    v_xor_b32 v24, 128, v23
    s_waitcnt vmcnt(3)
    buffer_load_dwordx4 v24, s[44:47], s59 offen offset:2048 nt lds
    v_xor_b32 v24, 192, v23
    s_waitcnt vmcnt(3)
    buffer_load_dwordx4 v24, s[44:47], s59 offen offset:3072 nt lds
    s_add_u32 s59, s86, 65536
    s_add_u32 m0, s87, 65536
    v_xor_b32 v24, 0, v22
    s_waitcnt vmcnt(3)
    buffer_load_dwordx4 v24, s[44:47], s59 offen offset:0 nt lds
    v_xor_b32 v24, 64, v22
    s_waitcnt vmcnt(3)
    buffer_load_dwordx4 v24, s[44:47], s59 offen offset:1024 nt lds
    v_xor_b32 v24, 128, v22
    s_waitcnt vmcnt(3)
    buffer_load_dwordx4 v24, s[44:47], s59 offen offset:2048 nt lds
    v_xor_b32 v24, 192, v22
    s_waitcnt vmcnt(3)
    buffer_load_dwordx4 v24, s[44:47], s59 offen offset:3072 nt lds
    s_add_u32 s59, s86, 69632
    s_add_u32 m0, s87, 69632
    v_xor_b32 v24, 0, v23
    s_waitcnt vmcnt(3)
    buffer_load_dwordx4 v24, s[44:47], s59 offen offset:0 nt lds
    v_xor_b32 v24, 64, v23
    s_waitcnt vmcnt(3)
    buffer_load_dwordx4 v24, s[44:47], s59 offen offset:1024 nt lds
    v_xor_b32 v24, 128, v23
    s_waitcnt vmcnt(3)
    buffer_load_dwordx4 v24, s[44:47], s59 offen offset:2048 nt lds
    v_xor_b32 v24, 192, v23
    s_waitcnt vmcnt(3)
    buffer_load_dwordx4 v24, s[44:47], s59 offen offset:3072 nt lds
    s_mov_b32 s36, s12
    s_mov_b32 s37, s13
    s_mov_b32 s38, 4194304
    s_mov_b32 s39, 0x20000
    s_mov_b32 s40, s14
    s_mov_b32 s41, s15
    s_mov_b32 s42, 4194304
    s_mov_b32 s43, 0x20000
    v_lshlrev_b32 v31, 13, v3
    v_lshl_add_u32 v31, v18, 4, v31
    s_lshl_b32 s3, s35, 16
    s_lshr_b32 s61, s32, 2
    s_lshl_b32 s61, s61, 15
    s_add_u32 s3, s3, s61
    s_and_b32 s61, s32, 3
    s_lshl_b32 s61, s61, 8
    s_add_u32 s3, s3, s61
    v_and_b32 v9, 3, v18
    v_lshlrev_b32 v9, 2, v9
    v_lshrrev_b32 v10, 2, v18
    v_sub_u32 v10, 0, v10
    v_and_or_b32 v9, v10, 3, v9
    v_xor_b32 v9, v9, v3
    v_lshlrev_b32 v9, 4, v9
    v_lshl_add_u32 v9, v18, 10, v9
    s_and_b32 s60, s32, 3
    s_lshl_b32 s60, s60, 14
    v_add_u32 v12, s60, v9
    v_xor_b32 v13, 64, v12
    v_xor_b32 v14, 128, v12
    v_xor_b32 v15, 192, v12
    v_bfe_u32 v9, v0, 2, 2
    v_lshrrev_b32 v10, 5, v0
    v_lshlrev_b32 v11, 13, v10
    v_lshl_add_u32 v11, v9, 10, v11
    v_lshlrev_b32 v9, 2, v9
    v_lshlrev_b32 v10, 1, v10
    v_or_b32 v9, v9, v10
    v_bfe_u32 v10, v0, 4, 1
    v_lshlrev_b32 v10, 1, v10
    v_bfe_u32 v4, v0, 1, 1
    v_or_b32 v10, v10, v4
    s_and_b32 s60, s32, 1
    s_lshl_b32 s60, s60, 3
    v_or_b32 v10, s60, v10
    v_xor_b32 v9, v9, v10
    v_lshl_add_u32 v11, v9, 4, v11
    v_and_b32 v9, 1, v0
    v_lshl_add_u32 v11, v9, 3, v11
    s_lshr_b32 s60, s32, 1
    s_lshl_b32 s60, s60, 8
    v_add_u32 v4, s60, v11
    v_xor_b32 v5, 48, v4
    v_add_u32 v5, 4096, v5
    v_xor_b32 v6, 64, v4
    v_xor_b32 v7, 64, v5
    s_lshr_b32 s60, s32, 2
    s_lshl_b32 s60, s60, 8
    s_add_u32 s60, s60, 131072
    v_lshl_add_u32 v16, v18, 4, s60
    v_and_b32 v17, 31, v0
    v_lshlrev_b32 v17, 4, v17
    v_add_u32 v17, 131072, v17
    s_and_b32 s61, s32, 3
    s_lshl_b32 s60, s61, 10
    v_lshrrev_b32 v9, 5, v0
    v_lshl_add_u32 v19, v9, 9, v16
    v_bfe_u32 v9, v0, 4, 1
    v_lshl_add_u32 v19, v9, 3, v19
    v_add_u32 v19, s60, v19
    s_lshl_b32 s61, s61, 2
    v_add_u32 v21, s61, v16
    v_add_u32 v25, 131072, v2
    v_mov_b32 v26, 4286578688
    v_mov_b32 v27, 4286578688
    v_mov_b32 v28, 0
    v_mov_b32 v96, 0
    v_mov_b32 v97, 0
    v_mov_b32 v98, 0
    v_mov_b32 v99, 0
    v_mov_b32 v100, 0
    v_mov_b32 v101, 0
    v_mov_b32 v102, 0
    v_mov_b32 v103, 0
    v_mov_b32 v104, 0
    v_mov_b32 v105, 0
    v_mov_b32 v106, 0
    v_mov_b32 v107, 0
    v_mov_b32 v108, 0
    v_mov_b32 v109, 0
    v_mov_b32 v110, 0
    v_mov_b32 v111, 0
    v_mov_b32 v112, 0
    v_mov_b32 v113, 0
    v_mov_b32 v114, 0
    v_mov_b32 v115, 0
    v_mov_b32 v116, 0
    v_mov_b32 v117, 0
    v_mov_b32 v118, 0
    v_mov_b32 v119, 0
    v_mov_b32 v120, 0
    v_mov_b32 v121, 0
    v_mov_b32 v122, 0
    v_mov_b32 v123, 0
    v_mov_b32 v124, 0
    v_mov_b32 v125, 0
    v_mov_b32 v126, 0
    v_mov_b32 v127, 0
    s_and_b32 s60, s35, 1
    s_lshl_b32 s61, s60, 11
    s_lshl_b32 s56, s32, 12
    s_add_u32 s58, s56, 131072
    s_add_u32 s56, s56, 65536
    s_sub_u32 s57, s56, s61
    s_add_u32 s56, s56, s61
    s_add_u32 s16, s56, 32768
    s_add_u32 s17, s57, 32768
    s_mul_i32 s60, s60, 2080
    s_and_b32 s61, s32, 3
    s_lshl_b32 s61, s61, 6
    s_xor_b32 s61, s61, s60
    v_xor_b32 v20, s61, v2
    v_add_u32 v20, s58, v20
    s_mov_b32 s58, 0xffff0000
    s_lshr_b32 s60, s32, 2
    s_lshl_b32 s60, s60, 14
    s_add_u32 s60, s60, 131072
    v_xor_b32 v29, v3, v18
    v_lshlrev_b32 v29, 4, v29
    v_lshl_add_u32 v29, v18, 10, v29
    v_add_u32 v29, s60, v29
    s_waitcnt lgkmcnt(0)
    s_add_u32 s84, s84, 0x9e3779b9
    s_mov_b32 s85, s84
    s_cmp_lt_u32 s32, 4
    s_cbranch_scc0 L_A_np1
    s_and_b32 s60, s34, 7
    s_lshl_b32 s60, s60, 8
    s_lshl_b32 s61, s32, 6
    s_add_u32 s60, s60, s61
    s_add_u32 s60, s60, 1179648
    s_mov_b32 s83, 0
L_ql_22:
    s_load_dwordx16 s[64:79], s[30:31], s60 glc
    s_waitcnt lgkmcnt(0)
    s_xor_b64 s[64:65], s[64:65], s[84:85]
    s_xor_b64 s[66:67], s[66:67], s[84:85]
    s_xor_b64 s[68:69], s[68:69], s[84:85]
    s_xor_b64 s[70:71], s[70:71], s[84:85]
    s_xor_b64 s[72:73], s[72:73], s[84:85]
    s_xor_b64 s[74:75], s[74:75], s[84:85]
    s_xor_b64 s[76:77], s[76:77], s[84:85]
    s_xor_b64 s[78:79], s[78:79], s[84:85]
    s_or_b64 s[64:65], s[64:65], s[66:67]
    s_or_b64 s[64:65], s[64:65], s[68:69]
    s_or_b64 s[64:65], s[64:65], s[70:71]
    s_or_b64 s[64:65], s[64:65], s[72:73]
    s_or_b64 s[64:65], s[64:65], s[74:75]
    s_or_b64 s[64:65], s[64:65], s[76:77]
    s_or_b64 s[64:65], s[64:65], s[78:79]
    s_cbranch_scc0 L_ql_ok_23
    s_add_u32 s83, s83, 1
    s_cmp_lt_u32 s83, 1048576
    s_cbranch_scc1 L_ql_22
L_ql_ok_23:
L_A_np1:
    s_barrier
    buffer_load_dwordx4 v[192:195], v2, s[48:51], s56 offen offset:0 sc1
    buffer_load_dwordx4 v[196:199], v2, s[48:51], s16 offen offset:0 sc1
    buffer_load_dwordx4 v[200:203], v2, s[48:51], s56 offen offset:1024 sc1
    buffer_load_dwordx4 v[204:207], v2, s[48:51], s16 offen offset:1024 sc1
    s_barrier
    buffer_load_dwordx4 v[208:211], v2, s[48:51], s57 offen offset:2048 sc1
    buffer_load_dwordx4 v[212:215], v2, s[48:51], s17 offen offset:2048 sc1
    buffer_load_dwordx4 v[216:219], v2, s[48:51], s57 offen offset:3072 sc1
    buffer_load_dwordx4 v[220:223], v2, s[48:51], s17 offen offset:3072 sc1
    s_waitcnt vmcnt(6)
    v_lshlrev_b32 v10, 16, v192
    v_lshlrev_b32 v11, 16, v196
    v_and_b32 v192, s58, v192
    v_and_b32 v196, s58, v196
    v_add_f32 v10, v10, v11
    v_add_f32 v192, v192, v196
    v_cvt_pk_bf16_f32 v192, v10, v192
    v_lshlrev_b32 v10, 16, v193
    v_lshlrev_b32 v11, 16, v197
    v_and_b32 v193, s58, v193
    v_and_b32 v197, s58, v197
    v_add_f32 v10, v10, v11
    v_add_f32 v193, v193, v197
    v_cvt_pk_bf16_f32 v193, v10, v193
    v_lshlrev_b32 v10, 16, v194
    v_lshlrev_b32 v11, 16, v198
    v_and_b32 v194, s58, v194
    v_and_b32 v198, s58, v198
    v_add_f32 v10, v10, v11
    v_add_f32 v194, v194, v198
    v_cvt_pk_bf16_f32 v194, v10, v194
    v_lshlrev_b32 v10, 16, v195
    v_lshlrev_b32 v11, 16, v199
    v_and_b32 v195, s58, v195
    v_and_b32 v199, s58, v199
    v_add_f32 v10, v10, v11
    v_add_f32 v195, v195, v199
    v_cvt_pk_bf16_f32 v195, v10, v195
    v_xor_b32 v10, 0, v20
    ds_write_b128 v10, v[192:195]
    s_waitcnt vmcnt(4)
    v_lshlrev_b32 v10, 16, v200
    v_lshlrev_b32 v11, 16, v204
    v_and_b32 v200, s58, v200
    v_and_b32 v204, s58, v204
    v_add_f32 v10, v10, v11
    v_add_f32 v200, v200, v204
    v_cvt_pk_bf16_f32 v200, v10, v200
    v_lshlrev_b32 v10, 16, v201
    v_lshlrev_b32 v11, 16, v205
    v_and_b32 v201, s58, v201
    v_and_b32 v205, s58, v205
    v_add_f32 v10, v10, v11
    v_add_f32 v201, v201, v205
    v_cvt_pk_bf16_f32 v201, v10, v201
    v_lshlrev_b32 v10, 16, v202
    v_lshlrev_b32 v11, 16, v206
    v_and_b32 v202, s58, v202
    v_and_b32 v206, s58, v206
    v_add_f32 v10, v10, v11
    v_add_f32 v202, v202, v206
    v_cvt_pk_bf16_f32 v202, v10, v202
    v_lshlrev_b32 v10, 16, v203
    v_lshlrev_b32 v11, 16, v207
    v_and_b32 v203, s58, v203
    v_and_b32 v207, s58, v207
    v_add_f32 v10, v10, v11
    v_add_f32 v203, v203, v207
    v_cvt_pk_bf16_f32 v203, v10, v203
    v_xor_b32 v10, 1040, v20
    ds_write_b128 v10, v[200:203]
    s_waitcnt vmcnt(2)
    v_lshlrev_b32 v10, 16, v208
    v_lshlrev_b32 v11, 16, v212
    v_and_b32 v208, s58, v208
    v_and_b32 v212, s58, v212
    v_add_f32 v10, v10, v11
    v_add_f32 v208, v208, v212
    v_cvt_pk_bf16_f32 v208, v10, v208
    v_lshlrev_b32 v10, 16, v209
    v_lshlrev_b32 v11, 16, v213
    v_and_b32 v209, s58, v209
    v_and_b32 v213, s58, v213
    v_add_f32 v10, v10, v11
    v_add_f32 v209, v209, v213
    v_cvt_pk_bf16_f32 v209, v10, v209
    v_lshlrev_b32 v10, 16, v210
    v_lshlrev_b32 v11, 16, v214
    v_and_b32 v210, s58, v210
    v_and_b32 v214, s58, v214
    v_add_f32 v10, v10, v11
    v_add_f32 v210, v210, v214
    v_cvt_pk_bf16_f32 v210, v10, v210
    v_lshlrev_b32 v10, 16, v211
    v_lshlrev_b32 v11, 16, v215
    v_and_b32 v211, s58, v211
    v_and_b32 v215, s58, v215
    v_add_f32 v10, v10, v11
    v_add_f32 v211, v211, v215
    v_cvt_pk_bf16_f32 v211, v10, v211
    v_xor_b32 v10, 2080, v20
    ds_write_b128 v10, v[208:211]
    s_waitcnt vmcnt(0)
    v_lshlrev_b32 v10, 16, v216
    v_lshlrev_b32 v11, 16, v220
    v_and_b32 v216, s58, v216
    v_and_b32 v220, s58, v220
    v_add_f32 v10, v10, v11
    v_add_f32 v216, v216, v220
    v_cvt_pk_bf16_f32 v216, v10, v216
    v_lshlrev_b32 v10, 16, v217
    v_lshlrev_b32 v11, 16, v221
    v_and_b32 v217, s58, v217
    v_and_b32 v221, s58, v221
    v_add_f32 v10, v10, v11
    v_add_f32 v217, v217, v221
    v_cvt_pk_bf16_f32 v217, v10, v217
    v_lshlrev_b32 v10, 16, v218
    v_lshlrev_b32 v11, 16, v222
    v_and_b32 v218, s58, v218
    v_and_b32 v222, s58, v222
    v_add_f32 v10, v10, v11
    v_add_f32 v218, v218, v222
    v_cvt_pk_bf16_f32 v218, v10, v218
    v_lshlrev_b32 v10, 16, v219
    v_lshlrev_b32 v11, 16, v223
    v_and_b32 v219, s58, v219
    v_and_b32 v223, s58, v223
    v_add_f32 v10, v10, v11
    v_add_f32 v219, v219, v223
    v_cvt_pk_bf16_f32 v219, v10, v219
    v_xor_b32 v10, 3120, v20
    ds_write_b128 v10, v[216:219]
    s_waitcnt lgkmcnt(0)
    s_barrier
    v_xor_b32 v10, 0, v29
    ds_read_b128 v[32:35], v10 offset:0
    ds_read_b128 v[48:51], v10 offset:256
    ds_read_b128 v[64:67], v10 offset:512
    ds_read_b128 v[80:83], v10 offset:768
    v_xor_b32 v10, 64, v29
    ds_read_b128 v[36:39], v10 offset:0
    ds_read_b128 v[52:55], v10 offset:256
    ds_read_b128 v[68:71], v10 offset:512
    ds_read_b128 v[84:87], v10 offset:768
    s_waitcnt lgkmcnt(2)
    v_xor_b32 v10, 128, v29
    ds_read_b128 v[40:43], v10 offset:0
    ds_read_b128 v[56:59], v10 offset:256
    ds_read_b128 v[72:75], v10 offset:512
    ds_read_b128 v[88:91], v10 offset:768
    v_xor_b32 v10, 192, v29
    ds_read_b128 v[44:47], v10 offset:0
    ds_read_b128 v[60:63], v10 offset:256
    ds_read_b128 v[76:79], v10 offset:512
    ds_read_b128 v[92:95], v10 offset:768
    s_waitcnt lgkmcnt(0)
    s_barrier
    ds_read_b128 v[224:227], v12 offset:0
    ds_read_b128 v[228:231], v13 offset:0
    ds_read_b128 v[232:235], v14 offset:0
    ds_read_b128 v[236:239], v15 offset:0
    ds_read_b128 v[240:243], v12 offset:256
    ds_read_b128 v[244:247], v13 offset:256
    ds_read_b128 v[248:251], v14 offset:256
    ds_read_b128 v[252:255], v15 offset:256
    s_waitcnt lgkmcnt(7)
    v_mfma_f32_16x16x32_bf16 v[8:11], v[224:227], v[32:35], 0
    ds_read_b128 v[224:227], v12 offset:512
    s_waitcnt lgkmcnt(7)
    v_mfma_f32_16x16x32_bf16 v[8:11], v[228:231], v[36:39], v[8:11]
    ds_read_b128 v[228:231], v13 offset:512
    s_waitcnt lgkmcnt(7)
    v_mfma_f32_16x16x32_bf16 v[8:11], v[232:235], v[40:43], v[8:11]
    ds_read_b128 v[232:235], v14 offset:512
    s_waitcnt lgkmcnt(7)
    v_mfma_f32_16x16x32_bf16 v[8:11], v[236:239], v[44:47], v[8:11]
    ds_read_b128 v[236:239], v15 offset:512
    s_waitcnt lgkmcnt(7)
    v_mfma_f32_16x16x32_bf16 v[8:11], v[240:243], v[48:51], v[8:11]
    ds_read_b128 v[240:243], v12 offset:768
    s_waitcnt lgkmcnt(7)
    v_mfma_f32_16x16x32_bf16 v[8:11], v[244:247], v[52:55], v[8:11]
    ds_read_b128 v[244:247], v13 offset:768
    s_waitcnt lgkmcnt(7)
    v_mfma_f32_16x16x32_bf16 v[8:11], v[248:251], v[56:59], v[8:11]
    ds_read_b128 v[248:251], v14 offset:768
    s_waitcnt lgkmcnt(7)
    v_mfma_f32_16x16x32_bf16 v[8:11], v[252:255], v[60:63], v[8:11]
    ds_read_b128 v[252:255], v15 offset:768
    s_waitcnt lgkmcnt(7)
    v_mfma_f32_16x16x32_bf16 v[8:11], v[224:227], v[64:67], v[8:11]
    s_waitcnt lgkmcnt(6)
    v_mfma_f32_16x16x32_bf16 v[8:11], v[228:231], v[68:71], v[8:11]
    s_waitcnt lgkmcnt(5)
    v_mfma_f32_16x16x32_bf16 v[8:11], v[232:235], v[72:75], v[8:11]
    s_waitcnt lgkmcnt(4)
    v_mfma_f32_16x16x32_bf16 v[8:11], v[236:239], v[76:79], v[8:11]
    s_waitcnt lgkmcnt(3)
    v_mfma_f32_16x16x32_bf16 v[8:11], v[240:243], v[80:83], v[8:11]
    s_waitcnt lgkmcnt(2)
    v_mfma_f32_16x16x32_bf16 v[8:11], v[244:247], v[84:87], v[8:11]
    s_waitcnt lgkmcnt(1)
    v_mfma_f32_16x16x32_bf16 v[8:11], v[248:251], v[88:91], v[8:11]
    s_waitcnt lgkmcnt(0)
    v_mfma_f32_16x16x32_bf16 v[8:11], v[252:255], v[92:95], v[8:11]
    v_xor_b32 v12, 0x10000, v12
    v_xor_b32 v13, 0x10000, v13
    v_xor_b32 v14, 0x10000, v14
    v_xor_b32 v15, 0x10000, v15
    ds_read_b128 v[224:227], v12 offset:0
    ds_read_b128 v[228:231], v13 offset:0
    ds_read_b128 v[232:235], v14 offset:0
    ds_read_b128 v[236:239], v15 offset:0
    ds_read_b128 v[240:243], v12 offset:256
    ds_read_b128 v[244:247], v13 offset:256
    ds_read_b128 v[248:251], v14 offset:256
    ds_read_b128 v[252:255], v15 offset:256
    s_waitcnt lgkmcnt(7)
    v_mfma_f32_16x16x32_bf16 v[192:195], v[224:227], v[32:35], 0
    ds_read_b128 v[224:227], v12 offset:512
    s_waitcnt lgkmcnt(7)
    v_mfma_f32_16x16x32_bf16 v[192:195], v[228:231], v[36:39], v[192:195]
    ds_read_b128 v[228:231], v13 offset:512
    s_waitcnt lgkmcnt(7)
    v_mfma_f32_16x16x32_bf16 v[192:195], v[232:235], v[40:43], v[192:195]
    ds_read_b128 v[232:235], v14 offset:512
    s_waitcnt lgkmcnt(7)
    v_mfma_f32_16x16x32_bf16 v[192:195], v[236:239], v[44:47], v[192:195]
    ds_read_b128 v[236:239], v15 offset:512
    s_waitcnt lgkmcnt(7)
    v_mfma_f32_16x16x32_bf16 v[192:195], v[240:243], v[48:51], v[192:195]
    ds_read_b128 v[240:243], v12 offset:768
    s_waitcnt lgkmcnt(7)
    v_mfma_f32_16x16x32_bf16 v[192:195], v[244:247], v[52:55], v[192:195]
    ds_read_b128 v[244:247], v13 offset:768
    s_waitcnt lgkmcnt(7)
    v_mfma_f32_16x16x32_bf16 v[192:195], v[248:251], v[56:59], v[192:195]
    ds_read_b128 v[248:251], v14 offset:768
    s_waitcnt lgkmcnt(7)
    v_mfma_f32_16x16x32_bf16 v[192:195], v[252:255], v[60:63], v[192:195]
    ds_read_b128 v[252:255], v15 offset:768
    s_waitcnt lgkmcnt(7)
    v_mfma_f32_16x16x32_bf16 v[192:195], v[224:227], v[64:67], v[192:195]
    s_waitcnt lgkmcnt(6)
    v_mfma_f32_16x16x32_bf16 v[192:195], v[228:231], v[68:71], v[192:195]
    s_waitcnt lgkmcnt(5)
    v_mfma_f32_16x16x32_bf16 v[192:195], v[232:235], v[72:75], v[192:195]
    s_waitcnt lgkmcnt(4)
    v_mfma_f32_16x16x32_bf16 v[192:195], v[236:239], v[76:79], v[192:195]
    s_waitcnt lgkmcnt(3)
    v_mfma_f32_16x16x32_bf16 v[192:195], v[240:243], v[80:83], v[192:195]
    s_waitcnt lgkmcnt(2)
    v_mfma_f32_16x16x32_bf16 v[192:195], v[244:247], v[84:87], v[192:195]
    s_waitcnt lgkmcnt(1)
    v_mfma_f32_16x16x32_bf16 v[192:195], v[248:251], v[88:91], v[192:195]
    s_waitcnt lgkmcnt(0)
    v_mfma_f32_16x16x32_bf16 v[192:195], v[252:255], v[92:95], v[192:195]
    v_xor_b32 v12, 0x10000, v12
    v_xor_b32 v13, 0x10000, v13
    v_xor_b32 v14, 0x10000, v14
    v_xor_b32 v15, 0x10000, v15
    ds_read_b64_tr_b16 v[208:209], v4 offset:0
    ds_read_b64_tr_b16 v[210:211], v5 offset:0
    ds_read_b64_tr_b16 v[212:213], v6 offset:0
    ds_read_b64_tr_b16 v[214:215], v7 offset:0
    ds_read_b64_tr_b16 v[216:217], v4 offset:16384
    ds_read_b64_tr_b16 v[218:219], v5 offset:16384
    ds_read_b64_tr_b16 v[220:221], v6 offset:16384
    ds_read_b64_tr_b16 v[222:223], v7 offset:16384
    v_max3_f32 v29, v8, v9, v10
    v_max3_f32 v30, v11, v192, v193
    v_max3_f32 v29, v29, v194, v195
    v_max_f32 v29, v29, v30
    v_mov_b32 v30, v29
    s_nop 1
    v_permlane16_swap_b32 v29, v30
    v_max_f32 v29, v29, v30
    v_mov_b32 v30, v29
    s_nop 1
    v_permlane32_swap_b32 v29, v30
    v_max_f32 v29, v29, v30
    v_mul_f32 v29, s82, v29
    s_mov_b64 exec, 0xffff
    ds_write_b32 v21, v29
    s_mov_b64 exec, -1
    s_waitcnt lgkmcnt(0)
    s_barrier
    ds_read_b128 v[224:227], v16
    ds_read_b128 v[228:231], v17
    ds_read_b64_tr_b16 v[232:233], v4 offset:32768
    ds_read_b64_tr_b16 v[234:235], v5 offset:32768
    ds_read_b64_tr_b16 v[236:237], v6 offset:32768
    ds_read_b64_tr_b16 v[238:239], v7 offset:32768
    ds_read_b64_tr_b16 v[240:241], v4 offset:49152
    ds_read_b64_tr_b16 v[242:243], v5 offset:49152
    ds_read_b64_tr_b16 v[244:245], v6 offset:49152
    ds_read_b64_tr_b16 v[246:247], v7 offset:49152
    s_waitcnt lgkmcnt(9)
    v_max3_f32 v29, v224, v225, v26
    v_max3_f32 v29, v226, v227, v29
    v_sub_f32 v30, v26, v29
    v_mov_b32 v26, v29
    v_fma_f32 v8, v8, s82, -v29
    v_fma_f32 v9, v9, s82, -v29
    v_fma_f32 v10, v10, s82, -v29
    v_fma_f32 v11, v11, s82, -v29
    v_fma_f32 v192, v192, s82, -v29
    v_fma_f32 v193, v193, s82, -v29
    v_fma_f32 v194, v194, s82, -v29
    v_fma_f32 v195, v195, s82, -v29
    v_exp_f32 v8, v8
    v_exp_f32 v9, v9
    v_exp_f32 v10, v10
    v_exp_f32 v11, v11
    v_exp_f32 v192, v192
    v_exp_f32 v193, v193
    v_exp_f32 v194, v194
    v_exp_f32 v195, v195
    v_exp_f32 v30, v30
    v_add_f32 v196, v8, v9
    v_add_f32 v197, v10, v11
    v_cvt_pk_bf16_f32 v8, v8, v9
    v_cvt_pk_bf16_f32 v9, v10, v11
    ds_write_b64 v19, v[8:9] offset:1024
    v_add_f32 v198, v192, v193
    v_add_f32 v199, v194, v195
    v_cvt_pk_bf16_f32 v192, v192, v193
    v_cvt_pk_bf16_f32 v193, v194, v195
    ds_write_b64 v19, v[192:193] offset:5120
    v_add_f32 v29, v196, v197
    v_add_f32 v24, v198, v199
    v_add_f32 v29, v29, v24
    v_fma_f32 v28, v28, v30, v29
    v_xor_b32 v4, 0x10000, v4
    v_xor_b32 v5, 0x10000, v5
    v_xor_b32 v6, 0x10000, v6
    v_xor_b32 v7, 0x10000, v7
    s_waitcnt lgkmcnt(0)
    s_barrier
    ds_read_b128 v[192:195], v25 offset:1024
    ds_read_b128 v[196:199], v25 offset:2048
    ds_read_b128 v[200:203], v25 offset:3072
    ds_read_b128 v[204:207], v25 offset:4096
    v_max3_f32 v29, v228, v229, v27
    v_max3_f32 v29, v230, v231, v29
    v_sub_f32 v30, v27, v29
    v_mov_b32 v27, v29
    v_exp_f32 v30, v30
    s_waitcnt lgkmcnt(0)
    v_mfma_f32_32x32x16_bf16 v[96:111], v[208:211], v[192:195], v[96:111]
    v_mfma_f32_32x32x16_bf16 v[112:127], v[212:215], v[192:195], v[112:127]
    ds_read_b64_tr_b16 v[208:209], v4 offset:0
    ds_read_b64_tr_b16 v[210:211], v5 offset:0
    ds_read_b64_tr_b16 v[212:213], v6 offset:0
    ds_read_b64_tr_b16 v[214:215], v7 offset:0
    ds_read_b128 v[192:195], v25 offset:5120
    s_add_u32 s59, s86, 131072
    s_add_u32 m0, s87, 0
    v_xor_b32 v24, 0, v22
    buffer_load_dwordx4 v24, s[44:47], s59 offen offset:0 nt lds
    v_xor_b32 v24, 64, v22
    buffer_load_dwordx4 v24, s[44:47], s59 offen offset:1024 nt lds
    v_mfma_f32_32x32x16_bf16 v[96:111], v[216:219], v[196:199], v[96:111]
    v_mfma_f32_32x32x16_bf16 v[112:127], v[220:223], v[196:199], v[112:127]
    ds_read_b64_tr_b16 v[216:217], v4 offset:16384
    ds_read_b64_tr_b16 v[218:219], v5 offset:16384
    ds_read_b64_tr_b16 v[220:221], v6 offset:16384
    ds_read_b64_tr_b16 v[222:223], v7 offset:16384
    ds_read_b128 v[196:199], v25 offset:6144
    v_xor_b32 v24, 128, v22
    buffer_load_dwordx4 v24, s[44:47], s59 offen offset:2048 nt lds
    v_xor_b32 v24, 192, v22
    buffer_load_dwordx4 v24, s[44:47], s59 offen offset:3072 nt lds
    v_mfma_f32_32x32x16_bf16 v[96:111], v[232:235], v[200:203], v[96:111]
    v_mfma_f32_32x32x16_bf16 v[112:127], v[236:239], v[200:203], v[112:127]
    ds_read_b64_tr_b16 v[232:233], v4 offset:32768
    ds_read_b64_tr_b16 v[234:235], v5 offset:32768
    ds_read_b64_tr_b16 v[236:237], v6 offset:32768
    ds_read_b64_tr_b16 v[238:239], v7 offset:32768
    ds_read_b128 v[200:203], v25 offset:7168
    s_add_u32 s59, s86, 135168
    s_add_u32 m0, s87, 4096
    v_xor_b32 v24, 0, v23
    buffer_load_dwordx4 v24, s[44:47], s59 offen offset:0 nt lds
    v_xor_b32 v24, 64, v23
    buffer_load_dwordx4 v24, s[44:47], s59 offen offset:1024 nt lds
    v_mfma_f32_32x32x16_bf16 v[96:111], v[240:243], v[204:207], v[96:111]
    v_mfma_f32_32x32x16_bf16 v[112:127], v[244:247], v[204:207], v[112:127]
    s_waitcnt lgkmcnt(10)
    ds_read_b64_tr_b16 v[240:241], v4 offset:49152
    ds_read_b64_tr_b16 v[242:243], v5 offset:49152
    ds_read_b64_tr_b16 v[244:245], v6 offset:49152
    ds_read_b64_tr_b16 v[246:247], v7 offset:49152
    ds_read_b128 v[204:207], v25 offset:8192
    v_xor_b32 v24, 128, v23
    buffer_load_dwordx4 v24, s[44:47], s59 offen offset:2048 nt lds
    v_xor_b32 v24, 192, v23
    buffer_load_dwordx4 v24, s[44:47], s59 offen offset:3072 nt lds
    v_xor_b32 v4, 0x10000, v4
    v_xor_b32 v5, 0x10000, v5
    v_xor_b32 v6, 0x10000, v6
    v_xor_b32 v7, 0x10000, v7
    s_waitcnt lgkmcnt(0)
    s_barrier
    v_mfma_f32_32x32x16_bf16 v[96:111], v[208:211], v[192:195], v[96:111]
    v_mfma_f32_32x32x16_bf16 v[112:127], v[212:215], v[192:195], v[112:127]
    s_add_u32 s59, s86, 196608
    s_add_u32 m0, s87, 65536
    v_xor_b32 v24, 0, v22
    buffer_load_dwordx4 v24, s[44:47], s59 offen offset:0 nt lds
    v_xor_b32 v24, 64, v22
    buffer_load_dwordx4 v24, s[44:47], s59 offen offset:1024 nt lds
    v_mfma_f32_32x32x16_bf16 v[96:111], v[216:219], v[196:199], v[96:111]
    v_mfma_f32_32x32x16_bf16 v[112:127], v[220:223], v[196:199], v[112:127]
    v_xor_b32 v24, 128, v22
    buffer_load_dwordx4 v24, s[44:47], s59 offen offset:2048 nt lds
    v_xor_b32 v24, 192, v22
    buffer_load_dwordx4 v24, s[44:47], s59 offen offset:3072 nt lds
    v_mfma_f32_32x32x16_bf16 v[96:111], v[232:235], v[200:203], v[96:111]
    v_mfma_f32_32x32x16_bf16 v[112:127], v[236:239], v[200:203], v[112:127]
    s_add_u32 s59, s86, 200704
    s_add_u32 m0, s87, 69632
    v_xor_b32 v24, 0, v23
    buffer_load_dwordx4 v24, s[44:47], s59 offen offset:0 nt lds
    v_xor_b32 v24, 64, v23
    buffer_load_dwordx4 v24, s[44:47], s59 offen offset:1024 nt lds
    v_mfma_f32_32x32x16_bf16 v[96:111], v[240:243], v[204:207], v[96:111]
    v_mfma_f32_32x32x16_bf16 v[112:127], v[244:247], v[204:207], v[112:127]
    v_xor_b32 v24, 128, v23
    buffer_load_dwordx4 v24, s[44:47], s59 offen offset:2048 nt lds
    v_xor_b32 v24, 192, v23
    buffer_load_dwordx4 v24, s[44:47], s59 offen offset:3072 nt lds
    s_waitcnt vmcnt(8)
    s_barrier
    ds_read_b128 v[224:227], v12 offset:0
    ds_read_b128 v[228:231], v13 offset:0
    ds_read_b128 v[232:235], v14 offset:0
    ds_read_b128 v[236:239], v15 offset:0
    ds_read_b128 v[240:243], v12 offset:256
    ds_read_b128 v[244:247], v13 offset:256
    ds_read_b128 v[248:251], v14 offset:256
    ds_read_b128 v[252:255], v15 offset:256
    s_waitcnt lgkmcnt(7)
    v_mfma_f32_16x16x32_bf16 v[8:11], v[224:227], v[32:35], 0
    ds_read_b128 v[224:227], v12 offset:512
    s_waitcnt lgkmcnt(7)
    v_mfma_f32_16x16x32_bf16 v[8:11], v[228:231], v[36:39], v[8:11]
    ds_read_b128 v[228:231], v13 offset:512
    s_waitcnt lgkmcnt(7)
    v_mfma_f32_16x16x32_bf16 v[8:11], v[232:235], v[40:43], v[8:11]
    ds_read_b128 v[232:235], v14 offset:512
    s_waitcnt lgkmcnt(7)
    v_mfma_f32_16x16x32_bf16 v[8:11], v[236:239], v[44:47], v[8:11]
    ds_read_b128 v[236:239], v15 offset:512
    s_waitcnt lgkmcnt(7)
    v_mfma_f32_16x16x32_bf16 v[8:11], v[240:243], v[48:51], v[8:11]
    ds_read_b128 v[240:243], v12 offset:768
    s_waitcnt lgkmcnt(7)
    v_mfma_f32_16x16x32_bf16 v[8:11], v[244:247], v[52:55], v[8:11]
    ds_read_b128 v[244:247], v13 offset:768
    s_waitcnt lgkmcnt(7)
    v_mfma_f32_16x16x32_bf16 v[8:11], v[248:251], v[56:59], v[8:11]
    ds_read_b128 v[248:251], v14 offset:768
    s_waitcnt lgkmcnt(7)
    v_mfma_f32_16x16x32_bf16 v[8:11], v[252:255], v[60:63], v[8:11]
    ds_read_b128 v[252:255], v15 offset:768
    s_waitcnt lgkmcnt(7)
    v_mfma_f32_16x16x32_bf16 v[8:11], v[224:227], v[64:67], v[8:11]
    s_waitcnt lgkmcnt(6)
    v_mfma_f32_16x16x32_bf16 v[8:11], v[228:231], v[68:71], v[8:11]
    s_waitcnt lgkmcnt(5)
    v_mfma_f32_16x16x32_bf16 v[8:11], v[232:235], v[72:75], v[8:11]
    s_waitcnt lgkmcnt(4)
    v_mfma_f32_16x16x32_bf16 v[8:11], v[236:239], v[76:79], v[8:11]
    s_waitcnt lgkmcnt(3)
    v_mfma_f32_16x16x32_bf16 v[8:11], v[240:243], v[80:83], v[8:11]
    s_waitcnt lgkmcnt(2)
    v_mfma_f32_16x16x32_bf16 v[8:11], v[244:247], v[84:87], v[8:11]
    s_waitcnt lgkmcnt(1)
    v_mfma_f32_16x16x32_bf16 v[8:11], v[248:251], v[88:91], v[8:11]
    s_waitcnt lgkmcnt(0)
    v_mfma_f32_16x16x32_bf16 v[8:11], v[252:255], v[92:95], v[8:11]
    v_xor_b32 v12, 0x10000, v12
    v_xor_b32 v13, 0x10000, v13
    v_xor_b32 v14, 0x10000, v14
    v_xor_b32 v15, 0x10000, v15
    s_waitcnt vmcnt(0)
    s_barrier
    ds_read_b128 v[224:227], v12 offset:0
    ds_read_b128 v[228:231], v13 offset:0
    ds_read_b128 v[232:235], v14 offset:0
    ds_read_b128 v[236:239], v15 offset:0
    ds_read_b128 v[240:243], v12 offset:256
    ds_read_b128 v[244:247], v13 offset:256
    ds_read_b128 v[248:251], v14 offset:256
    ds_read_b128 v[252:255], v15 offset:256
    s_waitcnt lgkmcnt(7)
    v_mfma_f32_16x16x32_bf16 v[192:195], v[224:227], v[32:35], 0
    ds_read_b128 v[224:227], v12 offset:512
    s_waitcnt lgkmcnt(7)
    v_mfma_f32_16x16x32_bf16 v[192:195], v[228:231], v[36:39], v[192:195]
    ds_read_b128 v[228:231], v13 offset:512
    s_add_u32 s63, s62, 0
    buffer_load_dwordx4 v[128:131], v1, s[36:39], s63 offen nt
    s_waitcnt lgkmcnt(7)
    v_mfma_f32_16x16x32_bf16 v[192:195], v[232:235], v[40:43], v[192:195]
    ds_read_b128 v[232:235], v14 offset:512
    s_waitcnt lgkmcnt(7)
    v_mfma_f32_16x16x32_bf16 v[192:195], v[236:239], v[44:47], v[192:195]
    ds_read_b128 v[236:239], v15 offset:512
    s_waitcnt lgkmcnt(7)
    v_mfma_f32_16x16x32_bf16 v[192:195], v[240:243], v[48:51], v[192:195]
    ds_read_b128 v[240:243], v12 offset:768
    s_waitcnt lgkmcnt(7)
    v_mfma_f32_16x16x32_bf16 v[192:195], v[244:247], v[52:55], v[192:195]
    ds_read_b128 v[244:247], v13 offset:768
    s_add_u32 s63, s62, 8192
    buffer_load_dwordx4 v[132:135], v1, s[36:39], s63 offen nt
    s_waitcnt lgkmcnt(7)
    v_mfma_f32_16x16x32_bf16 v[192:195], v[248:251], v[56:59], v[192:195]
    ds_read_b128 v[248:251], v14 offset:768
    s_waitcnt lgkmcnt(7)
    v_mfma_f32_16x16x32_bf16 v[192:195], v[252:255], v[60:63], v[192:195]
    ds_read_b128 v[252:255], v15 offset:768
    s_waitcnt lgkmcnt(7)
    v_mfma_f32_16x16x32_bf16 v[192:195], v[224:227], v[64:67], v[192:195]
    s_waitcnt lgkmcnt(6)
    v_mfma_f32_16x16x32_bf16 v[192:195], v[228:231], v[68:71], v[192:195]
    s_add_u32 s63, s62, 16384
    buffer_load_dwordx4 v[136:139], v1, s[36:39], s63 offen nt
    s_waitcnt lgkmcnt(5)
    v_mfma_f32_16x16x32_bf16 v[192:195], v[232:235], v[72:75], v[192:195]
    s_waitcnt lgkmcnt(4)
    v_mfma_f32_16x16x32_bf16 v[192:195], v[236:239], v[76:79], v[192:195]
    s_waitcnt lgkmcnt(3)
    v_mfma_f32_16x16x32_bf16 v[192:195], v[240:243], v[80:83], v[192:195]
    s_waitcnt lgkmcnt(2)
    v_mfma_f32_16x16x32_bf16 v[192:195], v[244:247], v[84:87], v[192:195]
    s_add_u32 s63, s62, 24576
    buffer_load_dwordx4 v[140:143], v1, s[36:39], s63 offen nt
    s_waitcnt lgkmcnt(1)
    v_mfma_f32_16x16x32_bf16 v[192:195], v[248:251], v[88:91], v[192:195]
    s_waitcnt lgkmcnt(0)
    v_mfma_f32_16x16x32_bf16 v[192:195], v[252:255], v[92:95], v[192:195]
    v_xor_b32 v12, 0x10000, v12
    v_xor_b32 v13, 0x10000, v13
    v_xor_b32 v14, 0x10000, v14
    v_xor_b32 v15, 0x10000, v15
    ds_read_b64_tr_b16 v[208:209], v4 offset:0
    ds_read_b64_tr_b16 v[210:211], v5 offset:0
    ds_read_b64_tr_b16 v[212:213], v6 offset:0
    ds_read_b64_tr_b16 v[214:215], v7 offset:0
    ds_read_b64_tr_b16 v[216:217], v4 offset:16384
    ds_read_b64_tr_b16 v[218:219], v5 offset:16384
    ds_read_b64_tr_b16 v[220:221], v6 offset:16384
    ds_read_b64_tr_b16 v[222:223], v7 offset:16384
    v_max3_f32 v29, v8, v9, v10
    v_max3_f32 v30, v11, v192, v193
    v_max3_f32 v29, v29, v194, v195
    v_max_f32 v29, v29, v30
    v_mov_b32 v30, v29
    s_nop 1
    v_permlane16_swap_b32 v29, v30
    v_max_f32 v29, v29, v30
    v_mov_b32 v30, v29
    s_nop 1
    v_permlane32_swap_b32 v29, v30
    v_max_f32 v29, v29, v30
    v_mul_f32 v29, s82, v29
    s_mov_b64 exec, 0xffff
    ds_write_b32 v21, v29
    s_mov_b64 exec, -1
    s_waitcnt lgkmcnt(0)
    s_barrier
    ds_read_b128 v[224:227], v16
    ds_read_b128 v[228:231], v17
    ds_read_b64_tr_b16 v[232:233], v4 offset:32768
    ds_read_b64_tr_b16 v[234:235], v5 offset:32768
    ds_read_b64_tr_b16 v[236:237], v6 offset:32768
    ds_read_b64_tr_b16 v[238:239], v7 offset:32768
    ds_read_b64_tr_b16 v[240:241], v4 offset:49152
    ds_read_b64_tr_b16 v[242:243], v5 offset:49152
    ds_read_b64_tr_b16 v[244:245], v6 offset:49152
    ds_read_b64_tr_b16 v[246:247], v7 offset:49152
    s_waitcnt lgkmcnt(9)
    v_max3_f32 v29, v224, v225, v26
    v_max3_f32 v29, v226, v227, v29
    v_sub_f32 v30, v26, v29
    v_mov_b32 v26, v29
    v_fma_f32 v8, v8, s82, -v29
    v_fma_f32 v9, v9, s82, -v29
    v_fma_f32 v10, v10, s82, -v29
    v_fma_f32 v11, v11, s82, -v29
    v_fma_f32 v192, v192, s82, -v29
    v_fma_f32 v193, v193, s82, -v29
    v_fma_f32 v194, v194, s82, -v29
    v_fma_f32 v195, v195, s82, -v29
    v_exp_f32 v8, v8
    v_exp_f32 v9, v9
    v_exp_f32 v10, v10
    v_exp_f32 v11, v11
    v_exp_f32 v192, v192
    v_exp_f32 v193, v193
    v_exp_f32 v194, v194
    v_exp_f32 v195, v195
    v_exp_f32 v30, v30
    v_add_f32 v196, v8, v9
    v_add_f32 v197, v10, v11
    v_cvt_pk_bf16_f32 v8, v8, v9
    v_cvt_pk_bf16_f32 v9, v10, v11
    ds_write_b64 v19, v[8:9] offset:1024
    v_add_f32 v198, v192, v193
    v_add_f32 v199, v194, v195
    v_cvt_pk_bf16_f32 v192, v192, v193
    v_cvt_pk_bf16_f32 v193, v194, v195
    ds_write_b64 v19, v[192:193] offset:5120
    v_add_f32 v29, v196, v197
    v_add_f32 v24, v198, v199
    v_add_f32 v29, v29, v24
    v_fma_f32 v28, v28, v30, v29
    v_xor_b32 v4, 0x10000, v4
    v_xor_b32 v5, 0x10000, v5
    v_xor_b32 v6, 0x10000, v6
    v_xor_b32 v7, 0x10000, v7
    s_waitcnt lgkmcnt(0)
    s_barrier
    ds_read_b128 v[192:195], v25 offset:1024
    ds_read_b128 v[196:199], v25 offset:2048
    ds_read_b128 v[200:203], v25 offset:3072
    ds_read_b128 v[204:207], v25 offset:4096
    v_max3_f32 v29, v228, v229, v27
    v_max3_f32 v29, v230, v231, v29
    v_sub_f32 v30, v27, v29
    v_mov_b32 v27, v29
    v_exp_f32 v30, v30
    s_nop 0
    v_mul_f32 v96, v30, v96
    v_mul_f32 v97, v30, v97
    v_mul_f32 v98, v30, v98
    v_mul_f32 v99, v30, v99
    v_mul_f32 v100, v30, v100
    v_mul_f32 v101, v30, v101
    v_mul_f32 v102, v30, v102
    v_mul_f32 v103, v30, v103
    v_mul_f32 v104, v30, v104
    v_mul_f32 v105, v30, v105
    v_mul_f32 v106, v30, v106
    v_mul_f32 v107, v30, v107
    v_mul_f32 v108, v30, v108
    v_mul_f32 v109, v30, v109
    v_mul_f32 v110, v30, v110
    v_mul_f32 v111, v30, v111
    v_mul_f32 v112, v30, v112
    v_mul_f32 v113, v30, v113
    v_mul_f32 v114, v30, v114
    v_mul_f32 v115, v30, v115
    v_mul_f32 v116, v30, v116
    v_mul_f32 v117, v30, v117
    v_mul_f32 v118, v30, v118
    v_mul_f32 v119, v30, v119
    v_mul_f32 v120, v30, v120
    v_mul_f32 v121, v30, v121
    v_mul_f32 v122, v30, v122
    v_mul_f32 v123, v30, v123
    v_mul_f32 v124, v30, v124
    v_mul_f32 v125, v30, v125
    v_mul_f32 v126, v30, v126
    v_mul_f32 v127, v30, v127
    s_waitcnt lgkmcnt(0)
    v_mfma_f32_32x32x16_bf16 v[96:111], v[208:211], v[192:195], v[96:111]
    v_mfma_f32_32x32x16_bf16 v[112:127], v[212:215], v[192:195], v[112:127]
    ds_read_b64_tr_b16 v[208:209], v4 offset:0
    ds_read_b64_tr_b16 v[210:211], v5 offset:0
    ds_read_b64_tr_b16 v[212:213], v6 offset:0
    ds_read_b64_tr_b16 v[214:215], v7 offset:0
    ds_read_b128 v[192:195], v25 offset:5120
    s_add_u32 s63, s62, 32768
    buffer_load_dwordx4 v[144:147], v1, s[36:39], s63 offen nt
    s_add_u32 s63, s62, 40960
    buffer_load_dwordx4 v[148:151], v1, s[36:39], s63 offen nt
    v_mfma_f32_32x32x16_bf16 v[96:111], v[216:219], v[196:199], v[96:111]
    v_mfma_f32_32x32x16_bf16 v[112:127], v[220:223], v[196:199], v[112:127]
    ds_read_b64_tr_b16 v[216:217], v4 offset:16384
    ds_read_b64_tr_b16 v[218:219], v5 offset:16384
    ds_read_b64_tr_b16 v[220:221], v6 offset:16384
    ds_read_b64_tr_b16 v[222:223], v7 offset:16384
    ds_read_b128 v[196:199], v25 offset:6144
    s_add_u32 s63, s62, 49152
    buffer_load_dwordx4 v[152:155], v1, s[36:39], s63 offen nt
    s_add_u32 s63, s62, 57344
    buffer_load_dwordx4 v[156:159], v1, s[36:39], s63 offen nt
    v_mfma_f32_32x32x16_bf16 v[96:111], v[232:235], v[200:203], v[96:111]
    v_mfma_f32_32x32x16_bf16 v[112:127], v[236:239], v[200:203], v[112:127]
    ds_read_b64_tr_b16 v[232:233], v4 offset:32768
    ds_read_b64_tr_b16 v[234:235], v5 offset:32768
    ds_read_b64_tr_b16 v[236:237], v6 offset:32768
    ds_read_b64_tr_b16 v[238:239], v7 offset:32768
    ds_read_b128 v[200:203], v25 offset:7168
    v_mfma_f32_32x32x16_bf16 v[96:111], v[240:243], v[204:207], v[96:111]
    v_mfma_f32_32x32x16_bf16 v[112:127], v[244:247], v[204:207], v[112:127]
    s_waitcnt lgkmcnt(10)
    ds_read_b64_tr_b16 v[240:241], v4 offset:49152
    ds_read_b64_tr_b16 v[242:243], v5 offset:49152
    ds_read_b64_tr_b16 v[244:245], v6 offset:49152
    ds_read_b64_tr_b16 v[246:247], v7 offset:49152
    ds_read_b128 v[204:207], v25 offset:8192
    v_xor_b32 v4, 0x10000, v4
    v_xor_b32 v5, 0x10000, v5
    v_xor_b32 v6, 0x10000, v6
    v_xor_b32 v7, 0x10000, v7
    s_waitcnt lgkmcnt(15)
    v_mfma_f32_32x32x16_bf16 v[96:111], v[208:211], v[192:195], v[96:111]
    v_mfma_f32_32x32x16_bf16 v[112:127], v[212:215], v[192:195], v[112:127]
    s_waitcnt lgkmcnt(10)
    v_mfma_f32_32x32x16_bf16 v[96:111], v[216:219], v[196:199], v[96:111]
    v_mfma_f32_32x32x16_bf16 v[112:127], v[220:223], v[196:199], v[112:127]
    s_waitcnt lgkmcnt(5)
    v_mfma_f32_32x32x16_bf16 v[96:111], v[232:235], v[200:203], v[96:111]
    v_mfma_f32_32x32x16_bf16 v[112:127], v[236:239], v[200:203], v[112:127]
    s_waitcnt lgkmcnt(0)
    v_mfma_f32_32x32x16_bf16 v[96:111], v[240:243], v[204:207], v[96:111]
    v_mfma_f32_32x32x16_bf16 v[112:127], v[244:247], v[204:207], v[112:127]
M_A_pub:
    v_mov_b32 v30, v28
    s_nop 1
    v_permlane16_swap_b32 v28, v30
    v_add_f32 v28, v28, v30
    v_mov_b32 v30, v28
    s_nop 1
    v_permlane32_swap_b32 v28, v30
    v_add_f32 v28, v28, v30
    s_mov_b64 exec, 0xffff
    ds_write_b32 v21, v28 offset:512
    s_mov_b64 exec, -1
    v_and_b32 v9, 31, v0
    v_mul_u32_u24 v9, 1040, v9
    v_lshrrev_b32 v10, 5, v0
    v_lshl_add_u32 v9, v10, 3, v9
    s_lshl_b32 s60, s32, 7
    v_add_u32 v9, s60, v9
    v_cvt_pk_bf16_f32 v96, v96, v97
    v_cvt_pk_bf16_f32 v97, v98, v99
    ds_write_b64 v9, v[96:97] offset:0
    v_cvt_pk_bf16_f32 v100, v100, v101
    v_cvt_pk_bf16_f32 v101, v102, v103
    ds_write_b64 v9, v[100:101] offset:16
    v_cvt_pk_bf16_f32 v104, v104, v105
    v_cvt_pk_bf16_f32 v105, v106, v107
    ds_write_b64 v9, v[104:105] offset:32
    v_cvt_pk_bf16_f32 v108, v108, v109
    v_cvt_pk_bf16_f32 v109, v110, v111
    ds_write_b64 v9, v[108:109] offset:48
    v_cvt_pk_bf16_f32 v112, v112, v113
    v_cvt_pk_bf16_f32 v113, v114, v115
    ds_write_b64 v9, v[112:113] offset:64
    v_cvt_pk_bf16_f32 v116, v116, v117
    v_cvt_pk_bf16_f32 v117, v118, v119
    ds_write_b64 v9, v[116:117] offset:80
    v_cvt_pk_bf16_f32 v120, v120, v121
    v_cvt_pk_bf16_f32 v121, v122, v123
    ds_write_b64 v9, v[120:121] offset:96
    v_cvt_pk_bf16_f32 v124, v124, v125
    v_cvt_pk_bf16_f32 v125, v126, v127
    ds_write_b64 v9, v[124:125] offset:112
    s_mul_i32 s60, s32, 4160
    v_add_u32 v9, s60, v2
    s_lshl_b32 s60, s32, 18
    s_lshl_b32 s61, s34, 10
    s_add_u32 s60, s60, s61
    s_add_u32 s60, s60, 2097152
    s_waitcnt lgkmcnt(0)
    s_barrier
    ds_read_b128 v[192:195], v9 offset:0
    ds_read_b128 v[196:199], v9 offset:1040
    ds_read_b128 v[200:203], v9 offset:2080
    ds_read_b128 v[204:207], v9 offset:3120
    ds_read_b128 v[224:227], v17 offset:512
    s_waitcnt lgkmcnt(4)
    s_add_u32 s61, s60, 0
    buffer_store_dwordx4 v[192:195], v2, s[48:51], s61 offen sc1
    s_waitcnt lgkmcnt(3)
    s_add_u32 s61, s60, 65536
    buffer_store_dwordx4 v[196:199], v2, s[48:51], s61 offen sc1
    s_waitcnt lgkmcnt(2)
    s_add_u32 s61, s60, 131072
    buffer_store_dwordx4 v[200:203], v2, s[48:51], s61 offen sc1
    s_waitcnt lgkmcnt(1)
    s_add_u32 s61, s60, 196608
    buffer_store_dwordx4 v[204:207], v2, s[48:51], s61 offen sc1
    s_waitcnt lgkmcnt(0)
    v_add_f32 v10, v224, v225
    v_add_f32 v11, v226, v227
    v_add_f32 v11, v10, v11
    v_mov_b32 v10, v27
    v_lshlrev_b32 v9, 9, v0
    s_lshl_b32 s60, s34, 3
    s_add_u32 s60, s60, 139264
    s_cmp_eq_u32 s32, 0
    s_cselect_b32 s60, s60, 8388608
    s_mov_b32 exec_hi, 0
    buffer_store_dwordx2 v[10:11], v9, s[48:51], s60 offen sc1
    s_mov_b64 exec, -1
    s_lshl_b32 s60, s34, 2
    s_add_u32 s60, s60, 1196032
    s_cmp_eq_u32 s32, 7
    s_cselect_b32 s60, s60, 8388608
    s_waitcnt vmcnt(0)
    s_barrier
    v_mov_b32 v20, s84
    v_lshlrev_b32 v21, 8, v0
    s_mov_b64 exec, 0xff
    buffer_store_dword v20, v21, s[48:51], s60 offen sc1
    s_mov_b64 exec, -1
    v_mov_b32 v22, v31
    v_perm_b32 v32, v132, v128, s80
    v_perm_b32 v36, v132, v128, s81
    v_perm_b32 v40, v133, v129, s80
    v_perm_b32 v44, v133, v129, s81
    v_perm_b32 v48, v134, v130, s80
    v_perm_b32 v52, v134, v130, s81
    v_perm_b32 v56, v135, v131, s80
    v_perm_b32 v60, v135, v131, s81
    v_perm_b32 v33, v140, v136, s80
    v_perm_b32 v37, v140, v136, s81
    v_perm_b32 v41, v141, v137, s80
    v_perm_b32 v45, v141, v137, s81
    v_perm_b32 v49, v142, v138, s80
    v_perm_b32 v53, v142, v138, s81
    v_perm_b32 v57, v143, v139, s80
    v_perm_b32 v61, v143, v139, s81
    v_perm_b32 v34, v148, v144, s80
    v_perm_b32 v38, v148, v144, s81
    v_perm_b32 v42, v149, v145, s80
    v_perm_b32 v46, v149, v145, s81
    v_perm_b32 v50, v150, v146, s80
    v_perm_b32 v54, v150, v146, s81
    v_perm_b32 v58, v151, v147, s80
    v_perm_b32 v62, v151, v147, s81
    v_perm_b32 v35, v156, v152, s80
    v_perm_b32 v39, v156, v152, s81
    v_perm_b32 v43, v157, v153, s80
    v_perm_b32 v47, v157, v153, s81
    v_perm_b32 v51, v158, v154, s80
    v_perm_b32 v55, v158, v154, s81
    v_perm_b32 v59, v159, v155, s80
    v_perm_b32 v63, v159, v155, s81
    v_and_b32 v9, 1, v0
    v_lshlrev_b32 v10, 3, v0
    s_lshl_b32 s60, s32, 7
    s_add_u32 s60, s60, 147456
    s_and_b32 s61, s35, 1
    s_lshl_b32 s61, s61, 2
    v_xor_b32 v16, s61, v0
    v_lshl_add_u32 v16, v16, 1, s60
    v_lshl_add_u32 v17, v9, 2, v3
    v_lshl_add_u32 v17, v17, 4, s60
    v_lshlrev_b32 v11, 4, v9
    v_lshl_add_u32 v11, v3, 2, v11
    v_bfe_u32 v12, v0, 3, 1
    v_lshlrev_b32 v12, 15, v12
    v_lshl_add_u32 v12, v3, 13, v12
    v_and_b32 v13, 7, v0
    v_lshl_add_u32 v12, v13, 4, v12
    s_lshr_b32 s58, s35, 1
    s_lshl_b32 s56, s58, 9
    s_add_u32 s56, s56, 139264
    s_lshl_b32 s57, s58, 16
    s_lshl_b32 s62, s32, 7
    s_add_u32 s57, s57, s62
    s_add_u32 s57, s57, 2097152
    s_and_b32 s59, s35, 1
    s_lshl_b32 s62, s59, 12
    s_add_u32 s58, s57, 4096
    s_sub_u32 s58, s58, s62
    s_add_u32 s57, s57, s62
    s_cmp_lt_u32 s32, 4
    s_cbranch_scc0 L_A_np2
    s_and_b32 s60, s34, 7
    s_lshl_b32 s60, s60, 8
    s_lshl_b32 s61, s32, 6
    s_add_u32 s60, s60, s61
    s_add_u32 s60, s60, 1196032
    s_mov_b32 s83, 0
L_cx_24:
    s_load_dwordx16 s[64:79], s[30:31], s60 glc
    s_waitcnt lgkmcnt(0)
    s_xor_b64 s[64:65], s[64:65], s[84:85]
    s_xor_b64 s[66:67], s[66:67], s[84:85]
    s_xor_b64 s[68:69], s[68:69], s[84:85]
    s_xor_b64 s[70:71], s[70:71], s[84:85]
    s_xor_b64 s[72:73], s[72:73], s[84:85]
    s_xor_b64 s[74:75], s[74:75], s[84:85]
    s_xor_b64 s[76:77], s[76:77], s[84:85]
    s_xor_b64 s[78:79], s[78:79], s[84:85]
    s_or_b64 s[64:65], s[64:65], s[66:67]
    s_or_b64 s[64:65], s[64:65], s[68:69]
    s_or_b64 s[64:65], s[64:65], s[70:71]
    s_or_b64 s[64:65], s[64:65], s[72:73]
    s_or_b64 s[64:65], s[64:65], s[74:75]
    s_or_b64 s[64:65], s[64:65], s[76:77]
    s_or_b64 s[64:65], s[64:65], s[78:79]
    s_cbranch_scc0 L_cx_ok_25
    s_add_u32 s83, s83, 1
    s_cmp_lt_u32 s83, 1048576
    s_cbranch_scc1 L_cx_24
L_cx_ok_25:
L_A_np2:
    s_barrier
    buffer_load_dwordx2 v[128:129], v10, s[48:51], s56 offen sc1
    buffer_load_dwordx4 v[192:195], v12, s[48:51], s57 offen offset:0 sc1
    buffer_load_dwordx4 v[196:199], v12, s[48:51], s57 offen offset:1024 sc1
    buffer_load_dwordx4 v[200:203], v12, s[48:51], s57 offen offset:2048 sc1
    buffer_load_dwordx4 v[204:207], v12, s[48:51], s57 offen offset:3072 sc1
    s_barrier
    buffer_load_dwordx4 v[208:211], v12, s[48:51], s58 offen offset:0 sc1
    buffer_load_dwordx4 v[212:215], v12, s[48:51], s58 offen offset:1024 sc1
    buffer_load_dwordx4 v[216:219], v12, s[48:51], s58 offen offset:2048 sc1
    buffer_load_dwordx4 v[220:223], v12, s[48:51], s58 offen offset:3072 sc1
    s_bfe_u32 s72, s84, 0xc0000
    s_bfe_u32 s73, s84, 0xc0007
    s_bfe_u32 s74, s84, 0xc000e
    s_bfe_u32 s75, s84, 0xc0014
    s_movk_i32 s76, 0xfff
    v_mov_b32 v23, 0xfffff000
    s_waitcnt vmcnt(8)
    v_max_f32_dpp v14, v128, v128 row_ror:8 row_mask:0xf bank_mask:0xf
    s_nop 1
    v_max_f32_dpp v14, v14, v14 row_ror:4 row_mask:0xf bank_mask:0xf
    s_nop 1
    v_max_f32_dpp v14, v14, v14 row_ror:2 row_mask:0xf bank_mask:0xf
    s_nop 1
    v_max_f32_dpp v14, v14, v14 row_ror:1 row_mask:0xf bank_mask:0xf
    v_mov_b32 v15, v14
    s_nop 1
    v_permlane16_swap_b32 v14, v15
    v_max_f32 v14, v14, v15
    v_mov_b32 v15, v14
    s_nop 1
    v_permlane32_swap_b32 v14, v15
    v_max_f32 v14, v14, v15
    v_sub_f32 v128, v128, v14
    v_exp_f32 v128, v128
    s_nop 0
    v_mul_f32 v14, v128, v129
    s_nop 1
    v_add_f32_dpp v14, v14, v14 row_ror:8 row_mask:0xf bank_mask:0xf
    s_nop 1
    v_add_f32_dpp v14, v14, v14 row_ror:4 row_mask:0xf bank_mask:0xf
    s_nop 1
    v_add_f32_dpp v14, v14, v14 row_ror:2 row_mask:0xf bank_mask:0xf
    s_nop 1
    v_add_f32_dpp v14, v14, v14 row_ror:1 row_mask:0xf bank_mask:0xf
    v_mov_b32 v15, v14
    s_nop 1
    v_permlane16_swap_b32 v14, v15
    v_add_f32 v14, v14, v15
    v_mov_b32 v15, v14
    s_nop 1
    v_permlane32_swap_b32 v14, v15
    v_add_f32 v14, v14, v15
    v_rcp_f32 v14, v14
    s_nop 0
    v_mul_f32 v128, v128, v14
    v_cvt_pk_bf16_f32 v128, v128, v128
    ds_write_b16 v16, v128
    ds_read_b128 v[28:31], v17
    s_lshl_b32 s61, s32, 8
    s_add_u32 s61, s61, 131072
    v_lshlrev_b32 v8, 5, v18
    v_lshl_add_u32 v8, v3, 3, v8
    v_add_u32 v8, s61, v8
    v_lshlrev_b32 v12, 2, v0
    v_add_u32 v12, 131072, v12
    s_lshl_b32 s61, s32, 7
    s_add_u32 s61, s61, 131072
    v_lshl_add_u32 v13, v0, 1, s61
    s_lshr_b32 s60, s32, 2
    s_lshl_b32 s63, s60, 6
    s_add_u32 s61, s61, s63
    v_lshl_add_u32 v9, v3, 4, s61
    s_lshl_b32 s62, s34, 1
    s_add_u32 s62, s62, s60
    s_lshl_b32 s62, s62, 11
    s_and_b32 s63, s32, 3
    s_lshl_b32 s63, s63, 9
    s_add_u32 s62, s62, s63
    s_add_u32 s62, s62, 851968
    v_lshlrev_b32 v10, 5, v18
    v_lshl_add_u32 v10, v3, 4, v10
    s_waitcnt vmcnt(6)
    s_add_u32 s63, s3, 0
    buffer_load_dwordx4 v[160:163], v22, s[40:43], s63 offen nt
    s_add_u32 s63, s3, 1024
    buffer_load_dwordx4 v[164:167], v22, s[40:43], s63 offen nt
    s_add_u32 s63, s3, 2048
    buffer_load_dwordx4 v[168:171], v22, s[40:43], s63 offen nt
    s_add_u32 s63, s3, 3072
    buffer_load_dwordx4 v[172:175], v22, s[40:43], s63 offen nt
    v_perm_b32 v224, v196, v192, s80
    v_perm_b32 v228, v196, v192, s81
    v_perm_b32 v232, v197, v193, s80
    v_perm_b32 v236, v197, v193, s81
    v_perm_b32 v240, v198, v194, s80
    v_perm_b32 v244, v198, v194, s81
    v_perm_b32 v248, v199, v195, s80
    v_perm_b32 v252, v199, v195, s81
    s_waitcnt vmcnt(8)
    s_add_u32 s63, s3, 4096
    buffer_load_dwordx4 v[176:179], v22, s[40:43], s63 offen nt
    s_add_u32 s63, s3, 5120
    buffer_load_dwordx4 v[180:183], v22, s[40:43], s63 offen nt
    s_add_u32 s63, s3, 6144
    buffer_load_dwordx4 v[184:187], v22, s[40:43], s63 offen nt
    s_add_u32 s63, s3, 7168
    buffer_load_dwordx4 v[188:191], v22, s[40:43], s63 offen nt
    v_perm_b32 v225, v204, v200, s80
    v_perm_b32 v229, v204, v200, s81
    v_perm_b32 v233, v205, v201, s80
    v_perm_b32 v237, v205, v201, s81
    v_perm_b32 v241, v206, v202, s80
    v_perm_b32 v245, v206, v202, s81
    v_perm_b32 v249, v207, v203, s80
    v_perm_b32 v253, v207, v203, s81
    s_waitcnt vmcnt(10)
    v_perm_b32 v226, v212, v208, s80
    v_perm_b32 v230, v212, v208, s81
    v_perm_b32 v234, v213, v209, s80
    v_perm_b32 v238, v213, v209, s81
    v_perm_b32 v242, v214, v210, s80
    v_perm_b32 v246, v214, v210, s81
    v_perm_b32 v250, v215, v211, s80
    v_perm_b32 v254, v215, v211, s81
    s_waitcnt vmcnt(8)
    v_perm_b32 v227, v220, v216, s80
    v_perm_b32 v231, v220, v216, s81
    v_perm_b32 v235, v221, v217, s80
    v_perm_b32 v239, v221, v217, s81
    v_perm_b32 v243, v222, v218, s80
    v_perm_b32 v247, v222, v218, s81
    v_perm_b32 v251, v223, v219, s80
    v_perm_b32 v255, v223, v219, s81
    s_waitcnt lgkmcnt(0)
    v_mfma_f32_16x16x32_bf16 v[96:99], v[28:31], v[224:227], 0
    v_mfma_f32_16x16x32_bf16 v[100:103], v[28:31], v[228:231], 0
    v_mfma_f32_16x16x32_bf16 v[104:107], v[28:31], v[232:235], 0
    v_mfma_f32_16x16x32_bf16 v[108:111], v[28:31], v[236:239], 0
    v_mfma_f32_16x16x32_bf16 v[112:115], v[28:31], v[240:243], 0
    v_mfma_f32_16x16x32_bf16 v[116:119], v[28:31], v[244:247], 0
    v_mfma_f32_16x16x32_bf16 v[120:123], v[28:31], v[248:251], 0
    v_mfma_f32_16x16x32_bf16 v[124:127], v[28:31], v[252:255], 0
    s_nop 0
    v_add_f32_dpp v128, v97, v96 row_shl:8 row_mask:0xf bank_mask:0xf
    v_add_f32_dpp v129, v101, v100 row_shl:8 row_mask:0xf bank_mask:0xf
    v_add_f32_dpp v130, v105, v104 row_shl:8 row_mask:0xf bank_mask:0xf
    v_add_f32_dpp v131, v109, v108 row_shl:8 row_mask:0xf bank_mask:0xf
    v_add_f32_dpp v132, v113, v112 row_shl:8 row_mask:0xf bank_mask:0xf
    v_add_f32_dpp v133, v117, v116 row_shl:8 row_mask:0xf bank_mask:0xf
    v_add_f32_dpp v134, v121, v120 row_shl:8 row_mask:0xf bank_mask:0xf
    v_add_f32_dpp v135, v125, v124 row_shl:8 row_mask:0xf bank_mask:0xf
    v_cvt_pk_bf16_f32 v136, v128, v129
    v_cvt_pk_bf16_f32 v137, v130, v131
    v_cvt_pk_bf16_f32 v138, v132, v133
    v_cvt_pk_bf16_f32 v139, v134, v135
    ds_bpermute_b32 v28, v11, v136
    ds_bpermute_b32 v29, v11, v137
    ds_bpermute_b32 v30, v11, v138
    ds_bpermute_b32 v31, v11, v139
    s_waitcnt lgkmcnt(0)
    v_mfma_f32_16x16x32_bf16 v[96:99], v[28:31], v[32:35], 0
    v_mfma_f32_16x16x32_bf16 v[100:103], v[28:31], v[36:39], 0
    v_mfma_f32_16x16x32_bf16 v[104:107], v[28:31], v[40:43], 0
    v_mfma_f32_16x16x32_bf16 v[108:111], v[28:31], v[44:47], 0
    v_mfma_f32_16x16x32_bf16 v[112:115], v[28:31], v[48:51], 0
    v_mfma_f32_16x16x32_bf16 v[116:119], v[28:31], v[52:55], 0
    v_mfma_f32_16x16x32_bf16 v[120:123], v[28:31], v[56:59], 0
    v_mfma_f32_16x16x32_bf16 v[124:127], v[28:31], v[60:63], 0
    s_nop 0
    v_add_f32_dpp v128, v97, v96 row_shl:8 row_mask:0xf bank_mask:0xf
    v_add_f32_dpp v129, v101, v100 row_shl:8 row_mask:0xf bank_mask:0xf
    v_add_f32_dpp v130, v105, v104 row_shl:8 row_mask:0xf bank_mask:0xf
    v_add_f32_dpp v131, v109, v108 row_shl:8 row_mask:0xf bank_mask:0xf
    v_add_f32_dpp v132, v113, v112 row_shl:8 row_mask:0xf bank_mask:0xf
    v_add_f32_dpp v133, v117, v116 row_shl:8 row_mask:0xf bank_mask:0xf
    v_add_f32_dpp v134, v121, v120 row_shl:8 row_mask:0xf bank_mask:0xf
    v_add_f32_dpp v135, v125, v124 row_shl:8 row_mask:0xf bank_mask:0xf
    v_cndmask_b32 v128, v128, v130, s[88:89]
    v_cndmask_b32 v132, v132, v134, s[88:89]
    v_cndmask_b32 v129, v129, v131, s[88:89]
    v_cndmask_b32 v133, v133, v135, s[88:89]
    s_mov_b32 vcc_lo, 0
    s_mov_b32 vcc_hi, -1
    v_cndmask_b32 v128, v128, v132, vcc
    v_cndmask_b32 v129, v129, v133, vcc
    s_mov_b32 exec_lo, 0x00ff00ff
    s_mov_b32 exec_hi, 0x00ff00ff
    ds_write_b64 v8, v[128:129] offset:12288
    s_mov_b64 exec, -1
    s_waitcnt lgkmcnt(0)
    s_waitcnt vmcnt(6)
    v_perm_b32 v64, v164, v160, s80
    v_perm_b32 v68, v164, v160, s81
    v_perm_b32 v72, v165, v161, s80
    v_perm_b32 v76, v165, v161, s81
    v_perm_b32 v80, v166, v162, s80
    v_perm_b32 v84, v166, v162, s81
    v_perm_b32 v88, v167, v163, s80
    v_perm_b32 v92, v167, v163, s81
    s_waitcnt vmcnt(4)
    v_perm_b32 v65, v172, v168, s80
    v_perm_b32 v69, v172, v168, s81
    v_perm_b32 v73, v173, v169, s80
    v_perm_b32 v77, v173, v169, s81
    v_perm_b32 v81, v174, v170, s80
    v_perm_b32 v85, v174, v170, s81
    v_perm_b32 v89, v175, v171, s80
    v_perm_b32 v93, v175, v171, s81
    s_waitcnt vmcnt(2)
    v_perm_b32 v66, v180, v176, s80
    v_perm_b32 v70, v180, v176, s81
    v_perm_b32 v74, v181, v177, s80
    v_perm_b32 v78, v181, v177, s81
    v_perm_b32 v82, v182, v178, s80
    v_perm_b32 v86, v182, v178, s81
    v_perm_b32 v90, v183, v179, s80
    v_perm_b32 v94, v183, v179, s81
    s_waitcnt vmcnt(0)
    v_perm_b32 v67, v188, v184, s80
    v_perm_b32 v71, v188, v184, s81
    v_perm_b32 v75, v189, v185, s80
    v_perm_b32 v79, v189, v185, s81
    v_perm_b32 v83, v190, v186, s80
    v_perm_b32 v87, v190, v186, s81
    v_perm_b32 v91, v191, v187, s80
    v_perm_b32 v95, v191, v187, s81
    s_lshl_b32 s60, s34, 2
    s_add_u32 s60, s60, 1220608
    s_cmp_eq_u32 s32, 7
    s_cselect_b32 s60, s60, 8388608
    s_barrier
    v_mov_b32 v20, s84
    v_lshlrev_b32 v21, 8, v0
    s_mov_b64 exec, 0xff
    buffer_store_dword v20, v21, s[48:51], s60 offen sc1
    s_mov_b64 exec, -1
    ds_read2st64_b32 v[128:129], v12 offset0:48 offset1:49
    ds_read2st64_b32 v[130:131], v12 offset0:50 offset1:51
    ds_read2st64_b32 v[132:133], v12 offset0:52 offset1:53
    ds_read2st64_b32 v[134:135], v12 offset0:54 offset1:55
    s_waitcnt lgkmcnt(2)
    v_pk_add_f32 v[128:129], v[128:129], v[130:131]
    s_waitcnt lgkmcnt(0)
    v_pk_add_f32 v[132:133], v[132:133], v[134:135]
    v_pk_add_f32 v[128:129], v[128:129], v[132:133]
    v_add_f32 v128, v128, v129
    v_cvt_pk_bf16_f32 v128, v128, v128
    ds_write_b16 v13, v128 offset:14336
    ds_read_b128 v[28:31], v9 offset:14336
    s_waitcnt lgkmcnt(0)
    v_mfma_f32_16x16x32_bf16 v[96:99], v[28:31], v[64:67], 0
    v_mfma_f32_16x16x32_bf16 v[100:103], v[28:31], v[68:71], 0
    v_mfma_f32_16x16x32_bf16 v[104:107], v[28:31], v[72:75], 0
    v_mfma_f32_16x16x32_bf16 v[108:111], v[28:31], v[76:79], 0
    v_mfma_f32_16x16x32_bf16 v[112:115], v[28:31], v[80:83], 0
    v_mfma_f32_16x16x32_bf16 v[116:119], v[28:31], v[84:87], 0
    v_mfma_f32_16x16x32_bf16 v[120:123], v[28:31], v[88:91], 0
    v_mfma_f32_16x16x32_bf16 v[124:127], v[28:31], v[92:95], 0
    s_nop 4
    v_cndmask_b32 v12, v96, v112, s[88:89]
    v_cndmask_b32 v13, v100, v116, s[88:89]
    v_cndmask_b32 v14, v104, v120, s[88:89]
    v_cndmask_b32 v15, v108, v124, s[88:89]
    v_and_or_b32 v12, v12, v23, s72
    v_and_or_b32 v13, v13, v23, s73
    v_and_or_b32 v14, v14, v23, s74
    v_and_or_b32 v15, v15, v23, s75
    s_mov_b32 exec_hi, 0
    buffer_store_dwordx4 v[12:15], v10, s[48:51], s62 offen sc1
    s_mov_b64 exec, -1
    s_cmp_lt_u32 s32, 4
    s_cselect_b32 s60, s34, 99
    s_cmp_lt_u32 s60, 32
    s_cbranch_scc0 L_fin
    s_and_b32 s3, s34, 7
    s_lshl_b32 s3, s3, 2
    s_lshr_b32 s60, s34, 3
    s_add_u32 s3, s3, s60
    v_lshrrev_b32 v4, 2, v0
    v_lshlrev_b32 v4, 11, v4
    v_and_b32 v5, 3, v0
    v_lshl_add_u32 v4, v5, 4, v4
    s_bfe_u32 s72, s84, 0xc0000
    s_bfe_u32 s73, s84, 0xc0007
    s_bfe_u32 s74, s84, 0xc000e
    s_bfe_u32 s75, s84, 0xc0014
    s_movk_i32 s76, 0xfff
    s_lshl_b32 s61, s3, 6
    s_add_u32 s12, s61, 851968
    s_add_u32 s13, s12, 32768
    s_add_u32 s14, s12, 65536
    s_add_u32 s15, s12, 98304
    s_add_u32 s16, s12, 131072
    s_add_u32 s17, s12, 163840
    s_add_u32 s18, s12, 196608
    s_add_u32 s19, s12, 229376
    s_lshl_b32 s61, s3, 5
    s_add_u32 s61, s61, 0
    v_lshl_add_u32 v5, v5, 3, s61
    v_lshrrev_b32 v6, 4, v0
    v_lshl_add_u32 v5, v6, 1, v5
    s_and_b32 s60, s34, 7
    s_lshl_b32 s60, s60, 8
    s_lshl_b32 s61, s32, 6
    s_add_u32 s60, s60, s61
    s_add_u32 s60, s60, 1220608
    s_mov_b32 s83, 0
L_fh_26:
    s_load_dwordx16 s[64:79], s[30:31], s60 glc
    s_waitcnt lgkmcnt(0)
    s_xor_b64 s[64:65], s[64:65], s[84:85]
    s_xor_b64 s[66:67], s[66:67], s[84:85]
    s_xor_b64 s[68:69], s[68:69], s[84:85]
    s_xor_b64 s[70:71], s[70:71], s[84:85]
    s_xor_b64 s[72:73], s[72:73], s[84:85]
    s_xor_b64 s[74:75], s[74:75], s[84:85]
    s_xor_b64 s[76:77], s[76:77], s[84:85]
    s_xor_b64 s[78:79], s[78:79], s[84:85]
    s_or_b64 s[64:65], s[64:65], s[66:67]
    s_or_b64 s[64:65], s[64:65], s[68:69]
    s_or_b64 s[64:65], s[64:65], s[70:71]
    s_or_b64 s[64:65], s[64:65], s[72:73]
    s_or_b64 s[64:65], s[64:65], s[74:75]
    s_or_b64 s[64:65], s[64:65], s[76:77]
    s_or_b64 s[64:65], s[64:65], s[78:79]
    s_cbranch_scc0 L_fh_ok_27
    s_add_u32 s83, s83, 1
    s_cmp_lt_u32 s83, 1048576
    s_cbranch_scc1 L_fh_26
L_fh_ok_27:
    s_barrier
    s_cmp_eq_u32 s32, 0
    s_cbranch_scc0 L_fin
    s_bfe_u32 s72, s84, 0xc0000
    s_bfe_u32 s73, s84, 0xc0007
    s_bfe_u32 s74, s84, 0xc000e
    s_bfe_u32 s75, s84, 0xc0014
    s_movk_i32 s76, 0xfff
    buffer_load_dwordx4 v[64:67], v4, s[48:51], s12 offen sc1
    buffer_load_dwordx4 v[68:71], v4, s[48:51], s13 offen sc1
    buffer_load_dwordx4 v[72:75], v4, s[48:51], s14 offen sc1
    buffer_load_dwordx4 v[76:79], v4, s[48:51], s15 offen sc1
    buffer_load_dwordx4 v[80:83], v4, s[48:51], s16 offen sc1
    buffer_load_dwordx4 v[84:87], v4, s[48:51], s17 offen sc1
    buffer_load_dwordx4 v[88:91], v4, s[48:51], s18 offen sc1
    buffer_load_dwordx4 v[92:95], v4, s[48:51], s19 offen sc1
    s_mov_b32 s83, 0
L_fin_28:
    buffer_load_dwordx4 v[96:99], v4, s[48:51], s12 offen sc1
    buffer_load_dwordx4 v[100:103], v4, s[48:51], s13 offen sc1
    buffer_load_dwordx4 v[104:107], v4, s[48:51], s14 offen sc1
    buffer_load_dwordx4 v[108:111], v4, s[48:51], s15 offen sc1
    buffer_load_dwordx4 v[112:115], v4, s[48:51], s16 offen sc1
    buffer_load_dwordx4 v[116:119], v4, s[48:51], s17 offen sc1
    buffer_load_dwordx4 v[120:123], v4, s[48:51], s18 offen sc1
    buffer_load_dwordx4 v[124:127], v4, s[48:51], s19 offen sc1
    s_waitcnt vmcnt(8)
    v_xor_b32 v64, s72, v64
    v_xor_b32 v65, s73, v65
    v_xor_b32 v66, s74, v66
    v_xor_b32 v67, s75, v67
    v_xor_b32 v68, s72, v68
    v_xor_b32 v69, s73, v69
    v_xor_b32 v70, s74, v70
    v_xor_b32 v71, s75, v71
    v_xor_b32 v72, s72, v72
    v_xor_b32 v73, s73, v73
    v_xor_b32 v74, s74, v74
    v_xor_b32 v75, s75, v75
    v_xor_b32 v76, s72, v76
    v_xor_b32 v77, s73, v77
    v_xor_b32 v78, s74, v78
    v_xor_b32 v79, s75, v79
    v_xor_b32 v80, s72, v80
    v_xor_b32 v81, s73, v81
    v_xor_b32 v82, s74, v82
    v_xor_b32 v83, s75, v83
    v_xor_b32 v84, s72, v84
    v_xor_b32 v85, s73, v85
    v_xor_b32 v86, s74, v86
    v_xor_b32 v87, s75, v87
    v_xor_b32 v88, s72, v88
    v_xor_b32 v89, s73, v89
    v_xor_b32 v90, s74, v90
    v_xor_b32 v91, s75, v91
    v_xor_b32 v92, s72, v92
    v_xor_b32 v93, s73, v93
    v_xor_b32 v94, s74, v94
    v_xor_b32 v95, s75, v95
    v_or_b32 v6, v64, v65
    v_or_b32 v7, v66, v67
    v_or3_b32 v6, v6, v68, v69
    v_or3_b32 v7, v7, v70, v71
    v_or3_b32 v6, v6, v72, v73
    v_or3_b32 v7, v7, v74, v75
    v_or3_b32 v6, v6, v76, v77
    v_or3_b32 v7, v7, v78, v79
    v_or3_b32 v6, v6, v80, v81
    v_or3_b32 v7, v7, v82, v83
    v_or3_b32 v6, v6, v84, v85
    v_or3_b32 v7, v7, v86, v87
    v_or3_b32 v6, v6, v88, v89
    v_or3_b32 v7, v7, v90, v91
    v_or3_b32 v6, v6, v92, v93
    v_or3_b32 v7, v7, v94, v95
    v_or_b32 v6, v6, v7
    v_and_b32 v6, s76, v6
    v_cmp_ne_u32 vcc, 0, v6
    s_nop 3
    s_cbranch_vccz L_fin_ok_29
    buffer_load_dwordx4 v[64:67], v4, s[48:51], s12 offen sc1
    buffer_load_dwordx4 v[68:71], v4, s[48:51], s13 offen sc1
    buffer_load_dwordx4 v[72:75], v4, s[48:51], s14 offen sc1
    buffer_load_dwordx4 v[76:79], v4, s[48:51], s15 offen sc1
    buffer_load_dwordx4 v[80:83], v4, s[48:51], s16 offen sc1
    buffer_load_dwordx4 v[84:87], v4, s[48:51], s17 offen sc1
    buffer_load_dwordx4 v[88:91], v4, s[48:51], s18 offen sc1
    buffer_load_dwordx4 v[92:95], v4, s[48:51], s19 offen sc1
    s_waitcnt vmcnt(8)
    v_xor_b32 v96, s72, v96
    v_xor_b32 v97, s73, v97
    v_xor_b32 v98, s74, v98
    v_xor_b32 v99, s75, v99
    v_xor_b32 v100, s72, v100
    v_xor_b32 v101, s73, v101
    v_xor_b32 v102, s74, v102
    v_xor_b32 v103, s75, v103
    v_xor_b32 v104, s72, v104
    v_xor_b32 v105, s73, v105
    v_xor_b32 v106, s74, v106
    v_xor_b32 v107, s75, v107
    v_xor_b32 v108, s72, v108
    v_xor_b32 v109, s73, v109
    v_xor_b32 v110, s74, v110
    v_xor_b32 v111, s75, v111
    v_xor_b32 v112, s72, v112
    v_xor_b32 v113, s73, v113
    v_xor_b32 v114, s74, v114
    v_xor_b32 v115, s75, v115
    v_xor_b32 v116, s72, v116
    v_xor_b32 v117, s73, v117
    v_xor_b32 v118, s74, v118
    v_xor_b32 v119, s75, v119
    v_xor_b32 v120, s72, v120
    v_xor_b32 v121, s73, v121
    v_xor_b32 v122, s74, v122
    v_xor_b32 v123, s75, v123
    v_xor_b32 v124, s72, v124
    v_xor_b32 v125, s73, v125
    v_xor_b32 v126, s74, v126
    v_xor_b32 v127, s75, v127
    v_or_b32 v6, v96, v97
    v_or_b32 v7, v98, v99
    v_or3_b32 v6, v6, v100, v101
    v_or3_b32 v7, v7, v102, v103
    v_or3_b32 v6, v6, v104, v105
    v_or3_b32 v7, v7, v106, v107
    v_or3_b32 v6, v6, v108, v109
    v_or3_b32 v7, v7, v110, v111
    v_or3_b32 v6, v6, v112, v113
    v_or3_b32 v7, v7, v114, v115
    v_or3_b32 v6, v6, v116, v117
    v_or3_b32 v7, v7, v118, v119
    v_or3_b32 v6, v6, v120, v121
    v_or3_b32 v7, v7, v122, v123
    v_or3_b32 v6, v6, v124, v125
    v_or3_b32 v7, v7, v126, v127
    v_or_b32 v6, v6, v7
    v_and_b32 v6, s76, v6
    v_cmp_ne_u32 vcc, 0, v6
    s_nop 3
    s_cbranch_vccz L_fin_ok2_30
    s_add_u32 s83, s83, 1
    s_cmp_lt_u32 s83, 1048576
    s_cbranch_scc1 L_fin_28
L_fin_ok2_30:
    v_pk_add_f32 v[8:9], v[96:97], v[100:101]
    v_pk_add_f32 v[10:11], v[98:99], v[102:103]
    v_pk_add_f32 v[12:13], v[104:105], v[108:109]
    v_pk_add_f32 v[14:15], v[106:107], v[110:111]
    v_pk_add_f32 v[16:17], v[112:113], v[116:117]
    v_pk_add_f32 v[18:19], v[114:115], v[118:119]
    v_pk_add_f32 v[20:21], v[120:121], v[124:125]
    v_pk_add_f32 v[22:23], v[122:123], v[126:127]
    s_nop 0
    s_branch L_fin_ok_29_b
L_fin_ok_29:
    v_pk_add_f32 v[8:9], v[64:65], v[68:69]
    v_pk_add_f32 v[10:11], v[66:67], v[70:71]
    v_pk_add_f32 v[12:13], v[72:73], v[76:77]
    v_pk_add_f32 v[14:15], v[74:75], v[78:79]
    v_pk_add_f32 v[16:17], v[80:81], v[84:85]
    v_pk_add_f32 v[18:19], v[82:83], v[86:87]
    v_pk_add_f32 v[20:21], v[88:89], v[92:93]
    v_pk_add_f32 v[22:23], v[90:91], v[94:95]
    s_nop 1
L_fin_ok_29_b:
    v_pk_add_f32 v[8:9], v[8:9], v[12:13]
    v_pk_add_f32 v[10:11], v[10:11], v[14:15]
    v_pk_add_f32 v[16:17], v[16:17], v[20:21]
    v_pk_add_f32 v[18:19], v[18:19], v[22:23]
    v_pk_add_f32 v[8:9], v[8:9], v[16:17]
    v_pk_add_f32 v[10:11], v[10:11], v[18:19]
    s_nop 1
    v_permlane32_swap_b32 v8, v10
    v_permlane32_swap_b32 v9, v11
    v_add_f32 v8, v8, v10
    v_add_f32 v9, v9, v11
    s_nop 1
    v_permlane16_swap_b32 v8, v9
    v_add_f32 v8, v8, v9
    s_nop 1
    v_add_f32_dpp v8, v8, v8 row_ror:4 row_mask:0xf bank_mask:0xf
    s_nop 1
    v_add_f32_dpp v8, v8, v8 row_ror:8 row_mask:0xf bank_mask:0xf
    v_cvt_pk_bf16_f32 v8, v8, v8
    s_mov_b32 exec_lo, 0x000f000f
    s_mov_b32 exec_hi, 0x000f000f
    global_store_short v5, v8, s[26:27]
    s_mov_b32 s60, 155648
    s_cmp_eq_u32 s3, 0
    s_cselect_b32 s60, s60, 8388608
    s_mov_b64 exec, 1
    v_mov_b32 v14, s84
    buffer_store_dword v14, off, s[48:51], s60
    s_mov_b64 exec, -1
    s_branch L_fin
L_fin:
L_end:
    s_endpgm
.section .rodata,"a"
.p2align 6
.amdhsa_kernel concat_heads__compressed_kv_cla__gqa_block_cached__decode_kernel
.amdhsa_next_free_vgpr 256
.amdhsa_next_free_sgpr 102
.amdhsa_accum_offset 256
.amdhsa_group_segment_fixed_size 0
.amdhsa_kernarg_size 112
.amdhsa_user_sgpr_count 2
.amdhsa_user_sgpr_kernarg_segment_ptr 1
.amdhsa_system_sgpr_workgroup_id_x 1
.end_amdhsa_kernel
```
